```python
import torch

def _softmax(x, axis=-1):
    return torch.softmax(x, dim=axis)
def _gelu(x):
    return torch.nn.functional.gelu(x, approximate="tanh")
def _silu(x):
    return torch.nn.functional.silu(x)
def _sigmoid(x):
    return torch.sigmoid(x)
def _layernorm(x, axis=-1, eps=1e-5):
    m = x.mean(dim=axis, keepdim=True)
    v = x.var(dim=axis, keepdim=True, unbiased=False)
    return (x - m) / torch.sqrt(v + eps)
def _scatter_add(tgt, idx, src, axis=0):
    return tgt.clone().index_add_(axis, idx, src)
def _segment_sum(src, seg, n):
    out = torch.zeros((n,) + src.shape[1:], dtype=src.dtype)
    return out.index_add_(0, seg, src)
def _pad(x, pw):
    flat = tuple(v for pair in reversed(pw) for v in pair)
    return torch.nn.functional.pad(x, flat)

kernel_name = 'gated_mix__linear_kernel_hedgehog__dense_activation_mish__prompt'

def setup_inputs():

    _w = (lambda a: (lambda t: t.to(torch.bfloat16) if t.is_floating_point() else t)(torch.as_tensor(a)))
    def _A_setup():
        B, S, D, H = 1, 2048, 512, 32
        Dh = D // H
        return {
            "x": _w((lambda *s: torch.randn(*s, dtype=torch.bfloat16) * 0.05)(B, S, D)),
            "wqkv": _w((lambda *s: torch.randn(*s, dtype=torch.bfloat16) * 0.8)(D, 3 * D)),
            "w_phi": _w((lambda *s: torch.randn(*s, dtype=torch.bfloat16) * 0.8)(H, Dh, Dh) * (Dh ** -0.5)),
            "wo": _w((lambda *s: torch.randn(*s, dtype=torch.bfloat16) * 0.05)(D, D)),
        }
    _A_in = _A_setup()

    def _B_setup():
        B, S, D, F = 1, 2048, 512, 1792
        return {
            "x": _w((lambda *s: torch.randn(*s, dtype=torch.bfloat16) * 0.05)(B, S, D)),
            "w1": _w((lambda *s: torch.randn(*s, dtype=torch.bfloat16) * 6.4)(D, F) * (D ** -0.5)),
            "b1": _w((lambda *s: torch.randn(*s, dtype=torch.bfloat16) * 0.1)(F)),
            "w2": _w((lambda *s: torch.randn(*s, dtype=torch.bfloat16) * 0.1)(F, D) * (F ** -0.5)),
        }
    _B_in = _B_setup()

    return {
        "A_x": _A_in["x"],
        "A_wqkv": _A_in["wqkv"],
        "A_w_phi": _A_in["w_phi"],
        "A_wo": _A_in["wo"],
        "B_x": _B_in["x"],
        "B_w1": _B_in["w1"],
        "B_b1": _B_in["b1"],
        "B_w2": _B_in["w2"],
        "gate_w": _w((lambda *s: torch.randn(*s, dtype=torch.bfloat16) * 0.05)(512) * 16.0),
    }

def reference(A_x, A_wqkv, A_w_phi, A_wo, B_x, B_w1, B_b1, B_w2, gate_w):
    def _A_ref(x, wqkv, w_phi, wo):
        B, S, D = x.shape
        H = 32; Dh = D // H
        qkv = (lambda x, *d: x.permute(*d))((x @ wqkv).reshape(B, S, 3, H, Dh), 2, 0, 3, 1, 4)
        q, k, v = qkv[0], qkv[1], qkv[2]
        pq = torch.einsum("bhsd,hdf->bhsf", q, w_phi)
        pk = torch.einsum("bhsd,hdf->bhsf", k, w_phi)
        phi_q = torch.concatenate([_softmax(pq, axis=-1), _softmax(-pq, axis=-1)], axis=-1)
        phi_k = torch.concatenate([_softmax(pk, axis=-1), _softmax(-pk, axis=-1)], axis=-1)
        kv = torch.einsum("bhsf,bhsd->bhfd", phi_k, v)
        z  = torch.einsum("bhsf->bhf", phi_k)
        num = torch.einsum("bhqf,bhfd->bhqd", phi_q, kv)
        den = torch.einsum("bhqf,bhf->bhq", phi_q, z)[..., None] + 1e-6
        o = num / den
        return (lambda x, *d: x.permute(*d))(o, 0, 2, 1, 3).reshape(B, S, D) @ wo

    def _B_ref(x, w1, b1, w2):
        h = torch.einsum("bsd,df->bsf", x, w1) + b1
        sp = torch.log1p(torch.exp(-torch.abs(h))) + torch.where(h > 0, h, torch.zeros_like(h))
        act = h * torch.tanh(sp)
        return torch.einsum("bsf,fd->bsd", act, w2)

    x = A_x
    g = _sigmoid((x * gate_w).sum(-1, keepdims=True))
    a = _A_ref(x, A_wqkv, A_w_phi, A_wo)
    b = _B_ref(x, B_w1, B_b1, B_w2)
    return g * a + (1 - g) * b
```

```asm
; @launch grid=(256,1,1) block=(256,1,1) lds=163840
.amdgcn_target "amdgcn-amd-amdhsa--gfx950"
.text
.globl gated_mix__linear_kernel_hedgehog__dense_activation_mish__prompt_kernel
.p2align 8
.type gated_mix__linear_kernel_hedgehog__dense_activation_mish__prompt_kernel,@function
gated_mix__linear_kernel_hedgehog__dense_activation_mish__prompt_kernel:
    s_cmp_ge_u32 s2, 256
    s_cbranch_scc1 L_end
    s_load_dwordx2 s[4:5], s[0:1], 0
    s_load_dwordx2 s[8:9], s[0:1], 8
    s_load_dwordx2 s[12:13], s[0:1], 40
    s_load_dwordx2 s[24:25], s[0:1], 88
    s_load_dwordx2 s[44:45], s[0:1], 64
    s_load_dwordx2 s[36:37], s[0:1], 16
    s_load_dwordx2 s[40:41], s[0:1], 48
    s_getpc_b64 s[48:49]
    v_lshrrev_b32 v2, 6, v0
    v_and_b32 v0, 63, v0
    s_lshr_b32 s100, s2, 3
    v_readfirstlane_b32 s50, v2
    v_lshlrev_b32 v1, 4, v0
    s_and_b32 s48, s48, 0xffffff00
    s_lshl2_add_u32 s101, s100, s50
    s_and_b32 s101, s101, 63
    s_min_u32 s101, s101, 42
    s_lshl_b32 s101, s101, 10
    s_add_u32 s48, s48, s101
    s_addc_u32 s49, s49, 0
    v_mov_b32 v5, s49
    v_add_co_u32 v4, vcc, s48, v1
    s_nop 1
    v_addc_co_u32 v5, vcc, 0, v5, vcc
    global_load_dwordx4 v[192:195], v[4:5], off
    s_and_b32 s101, s2, 7
    s_lshr_b32 s51, s101, 2
    s_lshr_b32 s92, s100, 2
    s_lshl3_add_u32 s51, s51, s92
    s_and_b32 s52, s101, 3
    s_and_b32 s92, s100, 3
    s_lshl2_add_u32 s52, s52, s92
    s_lshr_b32 s53, s52, 1
    s_lshr_b32 s92, s100, 3
    s_lshl2_add_u32 s54, s101, s92
    s_and_b32 s55, s100, 7
    s_xor_b32 s55, s55, 1
    s_lshl_b32 s58, s50, 11
    s_lshl_b32 s59, s50, 12
    s_xor_b32 s57, s2, 8
    s_or_b32 s57, s57, s50
    s_lshl1_add_u32 s56, s52, s51
    s_lshl1_add_u32 s3, s54, s55
    s_lshl_b32 s92, s56, 7
    s_and_b32 s60, s92, 0x380
    s_add_u32 s61, s92, 128
    s_and_b32 s61, s61, 0x380
    s_add_u32 s62, s92, 256
    s_and_b32 s62, s62, 0x380
    s_add_u32 s63, s92, 384
    s_and_b32 s63, s63, 0x380
    s_add_u32 s64, s92, 512
    s_and_b32 s64, s64, 0x380
    s_add_u32 s65, s92, 640
    s_and_b32 s65, s65, 0x380
    s_add_u32 s66, s92, 768
    s_and_b32 s66, s66, 0x380
    s_add_u32 s67, s92, 896
    s_and_b32 s67, s67, 0x380
    s_mov_b32 s6, 2097152
    s_mov_b32 s7, 0x20000
    s_mov_b32 s10, 1572864
    s_mov_b32 s11, 0x20000
    s_mov_b32 s14, 1835008
    s_mov_b32 s15, 0x20000
    s_mov_b32 s26, 10485760
    s_mov_b32 s27, 0x20000
    s_mov_b32 s46, 1024
    s_mov_b32 s47, 0x20000
    s_mov_b32 s38, 16384
    s_mov_b32 s39, 0x20000
    s_mov_b32 s42, 3584
    s_mov_b32 s43, 0x20000
    v_lshrrev_b32 v62, 3, v0
    v_and_b32 v61, 7, v0
    v_lshrrev_b32 v2, 4, v0
    s_lshl2_add_u32 s92, s51, s50
    s_lshl_b32 s92, s92, 15
    v_xor_b32 v4, v61, v2
    v_lshl_add_u32 v4, v4, 4, s92
    v_lshl_add_u32 v4, v62, 10, v4
    v_xor_b32 v5, 64, v4
    v_add_u32 v5, 7168, v5
    v_add_u32 v6, 14336, v4
    v_add_u32 v7, 14336, v5
    v_and_b32 v2, 1, v2
    v_lshlrev_b32 v2, 2, v2
    v_xor_b32 v61, v61, v2
    v_lshlrev_b32 v61, 4, v61
    s_waitcnt lgkmcnt(0)
    s_load_dwordx2 s[16:17], s[0:1], 56
    s_mov_b32 s18, 1835008
    s_mov_b32 s19, 0x20000
    s_load_dwordx2 s[20:21], s[0:1], 24
    s_mov_b32 s22, 524288
    s_mov_b32 s23, 0x20000
    s_load_dwordx2 s[28:29], s[0:1], 72
    s_mov_b32 s30, 2097152
    s_mov_b32 s31, 0x20000
    s_load_dwordx2 s[32:33], s[0:1], 80
    s_mov_b32 s34, 256
    s_mov_b32 s35, 0x20000
    s_bitcmp1_b32 s52, 0
    s_cbranch_scc1 L_typeB
    s_lshl_b32 s48, s53, 7
    s_add_u32 s48, s48, 1024
    s_mul_i32 s49, s50, 49152
    s_add_u32 s49, s48, s49
    v_mul_u32_u24 v8, 3072, v62
    v_add3_u32 v8, v8, v61, s49
    v_add_u32 v9, 23552, v8
    v_add_u32 v10, 1024, v8
    v_add_u32 v11, 1024, v9
    s_mul_i32 s68, s60, 1536
    s_mul_i32 s69, s61, 1536
    s_add_u32 m0, s59, 0
    s_nop 0
    buffer_load_dwordx4 v4, s[4:7], s60 offen lds
    buffer_load_dwordx4 v5, s[4:7], s60 offen offset:1024 lds
    buffer_load_dwordx4 v6, s[4:7], s60 offen offset:2048 lds
    buffer_load_dwordx4 v7, s[4:7], s60 offen offset:3072 lds
    s_add_u32 m0, s59, 16384
    s_nop 0
    buffer_load_dwordx4 v8, s[8:11], s68 offen lds
    buffer_load_dwordx4 v9, s[8:11], s68 offen offset:1024 lds
    s_add_u32 m0, s59, 18432
    s_nop 0
    buffer_load_dwordx4 v10, s[8:11], s68 offen lds
    buffer_load_dwordx4 v11, s[8:11], s68 offen offset:1024 lds
    s_and_b32 s44, s53, 1
    s_mul_i32 s48, s53, 192
    s_lshl_b32 s49, s44, 6
    s_add_u32 s100, s48, s49
    s_xor_b32 s49, s44, 1
    s_lshl_b32 s49, s49, 7
    s_add_u32 s101, s48, s49
    s_mul_i32 s70, s62, 1536
    s_mul_i32 s71, s63, 1536
    s_mul_i32 s72, s64, 1536
    s_mul_i32 s73, s65, 1536
    s_mul_i32 s74, s66, 1536
    s_mul_i32 s75, s67, 1536
    v_lshrrev_b32 v208, 5, v0
    v_bfe_u32 v209, v0, 2, 2
    v_and_b32 v210, 16, v0
    v_and_b32 v211, 3, v0
    v_lshlrev_b32 v211, 3, v211
    v_lshl_or_b32 v211, v210, 1, v211
    v_lshrrev_b32 v2, 1, v209
    v_lshl_or_b32 v210, v2, 6, v211
    v_lshl_add_u32 v210, v209, 7, v210
    v_lshl_add_u32 v38, v208, 10, v210
    v_xor_b32 v39, 64, v38
    v_lshl_add_u32 v44, v208, 9, v210
    v_add_u32 v44, s59, v44
    v_xor_b32 v45, 64, v44
    v_add_u32 v40, 65536, v38
    v_add_u32 v41, 65536, v39
    v_add_u32 v46, 65536, v44
    v_add_u32 v47, 65536, v45
    v_add_u32 v42, 131072, v38
    v_add_u32 v43, 131072, v39
    v_add_u32 v48, 131072, v44
    v_add_u32 v49, 131072, v45
    v_lshl_add_u32 v50, v209, 6, v211
    v_lshl_add_u32 v50, v208, 9, v50
    v_add_u32 v51, 0x10000, v50
    v_add_u32 v52, 0x20000, v50
    v_bfe_u32 v2, v0, 1, 3
    v_xor_b32 v2, v2, v208
    v_lshlrev_b32 v2, 4, v2
    v_and_b32 v210, 31, v0
    v_lshl_add_u32 v2, v210, 7, v2
    v_add_u32 v160, s59, v2
    v_xor_b32 v161, 32, v160
    v_xor_b32 v162, 64, v160
    v_xor_b32 v163, 96, v160
    v_add_u32 v164, 65536, v160
    v_add_u32 v165, 65536, v161
    v_add_u32 v166, 65536, v162
    v_add_u32 v167, 65536, v163
    v_add_u32 v168, 131072, v160
    v_add_u32 v169, 131072, v161
    v_add_u32 v170, 131072, v162
    v_add_u32 v171, 131072, v163
    v_lshl_add_u32 v2, v208, 2, v209
    v_lshlrev_b32 v2, 5, v2
    v_and_b32 v210, 3, v0
    v_lshl_add_u32 v2, v210, 3, v2
    v_and_b32 v210, 16, v0
    v_lshl_add_u32 v2, v210, 5, v2
    v_add_u32 v172, 149504, v2
    v_mov_b32 v2, 0x3f80
    v_cmp_eq_u32 vcc, 0, v208
    s_nop 1
    v_cndmask_b32 v2, 0, v2, vcc
    v_accvgpr_write_b32 a186, v2
    v_accvgpr_write_b32 a187, 0
    v_accvgpr_write_b32 a188, 0
    v_accvgpr_write_b32 a189, 0
    v_accvgpr_write_b32 a177, 0
    v_accvgpr_write_b32 a179, 0
    v_accvgpr_write_b32 a181, 0
    v_accvgpr_write_b32 a183, 0
    v_accvgpr_write_b32 a184, 0
    v_accvgpr_write_b32 a185, 0
    s_mul_i32 s76, s60, 1792
    s_mul_i32 s77, s61, 1792
    s_mul_i32 s78, s62, 1792
    s_mul_i32 s79, s63, 1792
    s_mul_i32 s80, s64, 1792
    s_mul_i32 s81, s65, 1792
    s_mul_i32 s82, s66, 1792
    s_mul_i32 s83, s67, 1792
    s_mul_i32 s49, s50, 57344
    s_add_u32 s49, s49, s100
    v_mul_u32_u24 v12, 3584, v62
    v_add3_u32 v12, v12, v61, s49
    v_add_u32 v13, 27648, v12
    v_lshrrev_b32 v2, 2, v0
    v_mul_u32_u24 v14, 3584, v2
    v_and_b32 v2, 3, v0
    v_lshl_add_u32 v14, v2, 4, v14
    v_add_u32 v14, s101, v14
    v_add_u32 v15, 56320, v14
    v_add_u32 v16, 112640, v14
    v_add_u32 v17, 168960, v14
    s_add_u32 s48, s50, s56
    s_add_u32 s48, s48, 0
    s_and_b32 s48, s48, 7
    s_mul_i32 s100, s48, 229376
    s_add_u32 s48, s50, s56
    s_add_u32 s48, s48, 4
    s_and_b32 s48, s48, 7
    s_mul_i32 s101, s48, 229376
    s_add_u32 s48, s3, 0
    s_and_b32 s48, s48, 7
    s_lshl_b32 s84, s48, 10
    s_and_b32 s48, s48, 4
    s_lshl_b32 s48, s48, 14
    s_lshl4_add_u32 s92, s84, s48
    s_add_u32 s48, s3, 1
    s_and_b32 s48, s48, 7
    s_lshl_b32 s85, s48, 10
    s_and_b32 s48, s48, 4
    s_lshl_b32 s48, s48, 14
    s_lshl4_add_u32 s93, s85, s48
    s_add_u32 s48, s3, 2
    s_and_b32 s48, s48, 7
    s_lshl_b32 s86, s48, 10
    s_and_b32 s48, s48, 4
    s_lshl_b32 s48, s48, 14
    s_lshl4_add_u32 s94, s86, s48
    s_add_u32 s48, s3, 3
    s_and_b32 s48, s48, 7
    s_lshl_b32 s87, s48, 10
    s_and_b32 s48, s48, 4
    s_lshl_b32 s48, s48, 14
    s_lshl4_add_u32 s95, s87, s48
    s_add_u32 s48, s3, 4
    s_and_b32 s48, s48, 7
    s_lshl_b32 s88, s48, 10
    s_and_b32 s48, s48, 4
    s_lshl_b32 s48, s48, 14
    s_lshl4_add_u32 s96, s88, s48
    s_add_u32 s48, s3, 5
    s_and_b32 s48, s48, 7
    s_lshl_b32 s89, s48, 10
    s_and_b32 s48, s48, 4
    s_lshl_b32 s48, s48, 14
    s_lshl4_add_u32 s97, s89, s48
    s_add_u32 s48, s3, 6
    s_and_b32 s48, s48, 7
    s_lshl_b32 s90, s48, 10
    s_and_b32 s48, s48, 4
    s_lshl_b32 s48, s48, 14
    s_lshl4_add_u32 s98, s90, s48
    s_add_u32 s48, s3, 7
    s_and_b32 s48, s48, 7
    s_lshl_b32 s91, s48, 10
    s_and_b32 s48, s48, 4
    s_lshl_b32 s48, s48, 14
    s_lshl4_add_u32 s99, s91, s48
    v_lshl_add_u32 v2, v62, 10, v61
    v_lshl_add_u32 v2, s55, 7, v2
    s_lshl_b32 s48, s50, 18
    s_add_u32 s48, s48, 786432
    v_add_u32 v18, s48, v2
    v_add_u32 v20, 65536, v18
    s_mul_i32 s48, s50, 196608
    v_add_u32 v22, s48, v2
    v_add_u32 v24, 65536, v22
    v_lshl_add_u32 v26, s50, 17, v2
    v_add_u32 v19, 7168, v18
    v_add_u32 v21, 7168, v20
    v_add_u32 v23, 7168, v22
    v_add_u32 v25, 7168, v24
    v_add_u32 v27, 7168, v26
    s_mul_i32 s48, s54, 294912
    s_mul_i32 s49, s50, 36864
    s_add_u32 s48, s48, s49
    s_add_u32 s48, s48, 655360
    v_add_u32 v28, s48, v1
    v_add_u32 v29, 147456, v28
    v_add_u32 v30, 8192, v28
    v_add_u32 v31, 155648, v28
    v_add_u32 v32, 16384, v28
    v_add_u32 v33, 163840, v28
    v_add_u32 v34, 24576, v28
    v_add_u32 v35, 172032, v28
    v_add_u32 v36, 28672, v28
    v_add_u32 v37, 176128, v28
    s_lshl2_add_u32 s48, s51, s50
    s_mul_i32 s48, s48, 147456
    s_lshr_b32 s49, s53, 1
    s_mul_i32 s49, s49, 36864
    s_add_u32 s48, s48, s49
    s_lshl_b32 s49, s44, 12
    s_add_u32 s48, s48, s49
    s_add_u32 s48, s48, 671744
    v_add_u32 v61, s48, v1
    s_lshl3_add_u32 s48, s54, s50
    s_lshl_b32 s48, s48, 6
    s_add_u32 s48, s48, s55
    s_lshl_b32 s48, s48, 7
    v_and_b32 v2, 7, v0
    v_lshlrev_b32 v2, 4, v2
    v_lshl_add_u32 v2, v62, 10, v2
    v_add_u32 v59, s48, v2
    s_lshl2_add_u32 s48, s53, s50
    s_lshl_b32 s48, s48, 4
    s_lshl2_add_u32 s49, s51, s50
    s_lshl_b32 s49, s49, 7
    s_add_u32 s49, s49, 32768
    v_and_b32 v2, 31, v0
    v_lshl_add_u32 v53, v2, 2, s49
    s_add_u32 s46, s48, s51
    s_mov_b32 s56, 0x3f803f80
    v_accvgpr_write_b32 a160, s56
    v_accvgpr_write_b32 a161, s56
    v_accvgpr_write_b32 a162, s56
    v_accvgpr_write_b32 a163, s56
    s_add_u32 m0, s59, 32768
    s_nop 0
    buffer_load_dwordx4 v4, s[4:7], s61 offen lds
    buffer_load_dwordx4 v5, s[4:7], s61 offen offset:1024 lds
    buffer_load_dwordx4 v6, s[4:7], s61 offen offset:2048 lds
    buffer_load_dwordx4 v7, s[4:7], s61 offen offset:3072 lds
    s_add_u32 m0, s59, 49152
    s_nop 0
    buffer_load_dwordx4 v8, s[8:11], s69 offen lds
    buffer_load_dwordx4 v9, s[8:11], s69 offen offset:1024 lds
    s_add_u32 m0, s59, 51200
    s_nop 0
    buffer_load_dwordx4 v10, s[8:11], s69 offen lds
    buffer_load_dwordx4 v11, s[8:11], s69 offen offset:1024 lds
    v_and_b32 v214, 31, v0
    v_lshlrev_b32 v214, 1, v214
    s_lshl_b32 s49, s50, 9
    s_add_u32 m0, s49, 149504
    s_lshl_b32 s47, s53, 11
    s_add_u32 s49, s49, s47
    s_mov_b32 exec_hi, 0
    buffer_load_dwordx4 v1, s[36:39], s49 offen lds
    s_mov_b32 exec_hi, -1
    v_accvgpr_write_b32 a182, 0
    s_mul_i32 s47, s53, 192
    s_lshl_b32 s49, s44, 6
    s_add_u32 s49, s47, s49
    buffer_load_ushort a176, v214, s[40:43], s49 offen
    buffer_load_ushort a178, v214, s[40:43], s49 offen offset:64
    s_xor_b32 s49, s44, 1
    s_lshl_b32 s49, s49, 7
    s_add_u32 s49, s47, s49
    buffer_load_ushort a180, v214, s[40:43], s49 offen
    s_mov_b32 s41, 1
    s_lshr_b32 s36, s50, 1
    s_lshl1_add_u32 s36, s51, s36
    s_lshr_b32 s37, s52, 2
    s_lshl2_add_u32 s36, s36, s37
    s_lshl_b32 s36, s36, 7
    s_lshl2_add_u32 s37, s53, s50
    s_add_u32 s37, s37, 128
    s_lshl_b32 s37, s37, 7
    s_lshl2_add_u32 s38, s54, s50
    s_lshl_b32 s38, s38, 7
    s_lshl_b32 s49, s44, 11
    s_sub_u32 s53, 8192, s49
    s_mov_b32 s51, 0x3fb8aa3b
    s_mov_b32 s52, 0
    s_waitcnt lgkmcnt(0)
    s_waitcnt vmcnt(16)
    s_waitcnt vmcnt(12)
    s_barrier
    ds_read_b128 a[0:3], v160 offset:0
    ds_read_b64_tr_b16 a[192:193], v38 offset:16384
    ds_read_b64_tr_b16 a[194:195], v38 offset:16896
    ds_read_b64_tr_b16 a[196:197], v39 offset:16384
    ds_read_b64_tr_b16 a[198:199], v39 offset:16896
    ds_read_b64_tr_b16 a[200:201], v38 offset:18432
    ds_read_b64_tr_b16 a[202:203], v38 offset:18944
    ds_read_b64_tr_b16 a[204:205], v39 offset:18432
    ds_read_b64_tr_b16 a[206:207], v39 offset:18944
    ds_read_b128 a[4:7], v161 offset:0
    ds_read_b64_tr_b16 a[208:209], v38 offset:20480
    ds_read_b64_tr_b16 a[210:211], v38 offset:20992
    ds_read_b64_tr_b16 a[212:213], v39 offset:20480
    ds_read_b64_tr_b16 a[214:215], v39 offset:20992
    ds_read_b64_tr_b16 a[216:217], v38 offset:22528
    ds_read_b64_tr_b16 a[218:219], v38 offset:23040
    ds_read_b64_tr_b16 a[220:221], v39 offset:22528
    ds_read_b64_tr_b16 a[222:223], v39 offset:23040
    s_waitcnt lgkmcnt(9)
    v_mfma_f32_32x32x16_bf16 v[112:127], a[204:207], a[0:3], 0
    ds_read_b128 a[8:11], v162 offset:0
    ds_read_b64_tr_b16 a[224:225], v38 offset:24576
    ds_read_b64_tr_b16 a[226:227], v38 offset:25088
    s_add_u32 m0, s59, 65536
    s_nop 0
    buffer_load_dwordx4 v4, s[4:7], s62 offen lds
    v_mfma_f32_32x32x16_bf16 v[96:111], a[200:203], a[0:3], 0
    ds_read_b64_tr_b16 a[228:229], v39 offset:24576
    ds_read_b64_tr_b16 a[230:231], v39 offset:25088
    v_mfma_f32_32x32x16_bf16 v[80:95], a[196:199], a[0:3], 0
    ds_read_b64_tr_b16 a[232:233], v38 offset:26624
    ds_read_b64_tr_b16 a[234:235], v38 offset:27136
    buffer_load_dwordx4 v5, s[4:7], s62 offen offset:1024 lds
    v_mfma_f32_32x32x16_bf16 v[64:79], a[192:195], a[0:3], 0
    ds_read_b64_tr_b16 a[236:237], v39 offset:26624
    ds_read_b64_tr_b16 a[238:239], v39 offset:27136
    buffer_load_dwordx4 v6, s[4:7], s62 offen offset:2048 lds
    s_waitcnt lgkmcnt(9)
    v_mfma_f32_32x32x16_bf16 v[112:127], a[220:223], a[4:7], v[112:127]
    ds_read_b128 a[12:15], v163 offset:0
    ds_read_b64_tr_b16 a[240:241], v38 offset:28672
    ds_read_b64_tr_b16 a[242:243], v38 offset:29184
    v_mfma_f32_32x32x16_bf16 v[96:111], a[216:219], a[4:7], v[96:111]
    ds_read_b64_tr_b16 a[244:245], v39 offset:28672
    ds_read_b64_tr_b16 a[246:247], v39 offset:29184
    buffer_load_dwordx4 v7, s[4:7], s62 offen offset:3072 lds
    s_add_u32 m0, s59, 81920
    v_mfma_f32_32x32x16_bf16 v[80:95], a[212:215], a[4:7], v[80:95]
    ds_read_b64_tr_b16 a[248:249], v38 offset:30720
    ds_read_b64_tr_b16 a[250:251], v38 offset:31232
    buffer_load_dwordx4 v8, s[8:11], s70 offen lds
    v_mfma_f32_32x32x16_bf16 v[64:79], a[208:211], a[4:7], v[64:79]
    ds_read_b64_tr_b16 a[252:253], v39 offset:30720
    ds_read_b64_tr_b16 a[254:255], v39 offset:31232
    s_waitcnt lgkmcnt(9)
    v_mfma_f32_32x32x16_bf16 v[112:127], a[236:239], a[8:11], v[112:127]
    s_waitcnt vmcnt(13)
    s_waitcnt vmcnt(9)
    s_waitcnt lgkmcnt(0)
    s_barrier
    ds_read_b128 a[16:19], v160 offset:32768
    ds_read_b64_tr_b16 a[192:193], v38 offset:49152
    ds_read_b64_tr_b16 a[194:195], v38 offset:49664
    buffer_load_dwordx4 v9, s[8:11], s70 offen offset:1024 lds
    s_add_u32 m0, s59, 83968
    v_mfma_f32_32x32x16_bf16 v[96:111], a[232:235], a[8:11], v[96:111]
    ds_read_b64_tr_b16 a[196:197], v39 offset:49152
    ds_read_b64_tr_b16 a[198:199], v39 offset:49664
    buffer_load_dwordx4 v10, s[8:11], s70 offen lds
    v_mfma_f32_32x32x16_bf16 v[80:95], a[228:231], a[8:11], v[80:95]
    ds_read_b64_tr_b16 a[200:201], v38 offset:51200
    ds_read_b64_tr_b16 a[202:203], v38 offset:51712
    v_mfma_f32_32x32x16_bf16 v[64:79], a[224:227], a[8:11], v[64:79]
    ds_read_b64_tr_b16 a[204:205], v39 offset:51200
    ds_read_b64_tr_b16 a[206:207], v39 offset:51712
    buffer_load_dwordx4 v11, s[8:11], s70 offen offset:1024 lds
    s_add_u32 m0, s59, 98304
    v_mfma_f32_32x32x16_bf16 v[112:127], a[252:255], a[12:15], v[112:127]
    ds_read_b128 a[20:23], v161 offset:32768
    ds_read_b64_tr_b16 a[208:209], v38 offset:53248
    ds_read_b64_tr_b16 a[210:211], v38 offset:53760
    buffer_load_dwordx4 v4, s[4:7], s63 offen lds
    v_mfma_f32_32x32x16_bf16 v[96:111], a[248:251], a[12:15], v[96:111]
    ds_read_b64_tr_b16 a[212:213], v39 offset:53248
    ds_read_b64_tr_b16 a[214:215], v39 offset:53760
    v_mfma_f32_32x32x16_bf16 v[80:95], a[244:247], a[12:15], v[80:95]
    ds_read_b64_tr_b16 a[216:217], v38 offset:55296
    ds_read_b64_tr_b16 a[218:219], v38 offset:55808
    buffer_load_dwordx4 v5, s[4:7], s63 offen offset:1024 lds
    v_mfma_f32_32x32x16_bf16 v[64:79], a[240:243], a[12:15], v[64:79]
    ds_read_b64_tr_b16 a[220:221], v39 offset:55296
    ds_read_b64_tr_b16 a[222:223], v39 offset:55808
    buffer_load_dwordx4 v6, s[4:7], s63 offen offset:2048 lds
    s_waitcnt lgkmcnt(9)
    v_mfma_f32_32x32x16_bf16 v[112:127], a[204:207], a[16:19], v[112:127]
    ds_read_b128 a[24:27], v162 offset:32768
    ds_read_b64_tr_b16 a[224:225], v38 offset:57344
    ds_read_b64_tr_b16 a[226:227], v38 offset:57856
    v_mfma_f32_32x32x16_bf16 v[96:111], a[200:203], a[16:19], v[96:111]
    ds_read_b64_tr_b16 a[228:229], v39 offset:57344
    ds_read_b64_tr_b16 a[230:231], v39 offset:57856
    buffer_load_dwordx4 v7, s[4:7], s63 offen offset:3072 lds
    s_add_u32 m0, s59, 114688
    v_mfma_f32_32x32x16_bf16 v[80:95], a[196:199], a[16:19], v[80:95]
    ds_read_b64_tr_b16 a[232:233], v38 offset:59392
    ds_read_b64_tr_b16 a[234:235], v38 offset:59904
    buffer_load_dwordx4 v8, s[8:11], s71 offen lds
    v_mfma_f32_32x32x16_bf16 v[64:79], a[192:195], a[16:19], v[64:79]
    ds_read_b64_tr_b16 a[236:237], v39 offset:59392
    ds_read_b64_tr_b16 a[238:239], v39 offset:59904
    s_waitcnt lgkmcnt(9)
    v_mfma_f32_32x32x16_bf16 v[112:127], a[220:223], a[20:23], v[112:127]
    ds_read_b128 a[28:31], v163 offset:32768
    ds_read_b64_tr_b16 a[240:241], v38 offset:61440
    ds_read_b64_tr_b16 a[242:243], v38 offset:61952
    buffer_load_dwordx4 v9, s[8:11], s71 offen offset:1024 lds
    s_add_u32 m0, s59, 116736
    v_mfma_f32_32x32x16_bf16 v[96:111], a[216:219], a[20:23], v[96:111]
    ds_read_b64_tr_b16 a[244:245], v39 offset:61440
    ds_read_b64_tr_b16 a[246:247], v39 offset:61952
    buffer_load_dwordx4 v10, s[8:11], s71 offen lds
    v_mfma_f32_32x32x16_bf16 v[80:95], a[212:215], a[20:23], v[80:95]
    ds_read_b64_tr_b16 a[248:249], v38 offset:63488
    ds_read_b64_tr_b16 a[250:251], v38 offset:64000
    v_mfma_f32_32x32x16_bf16 v[64:79], a[208:211], a[20:23], v[64:79]
    ds_read_b64_tr_b16 a[252:253], v39 offset:63488
    ds_read_b64_tr_b16 a[254:255], v39 offset:64000
    buffer_load_dwordx4 v11, s[8:11], s71 offen offset:1024 lds
    s_add_u32 m0, s59, 131072
    s_waitcnt lgkmcnt(9)
    v_mfma_f32_32x32x16_bf16 v[112:127], a[236:239], a[24:27], v[112:127]
    s_waitcnt vmcnt(12)
    s_waitcnt vmcnt(8)
    s_waitcnt lgkmcnt(0)
    s_barrier
    ds_read_b64_tr_b16 a[168:169], v172 offset:0
    ds_read_b64_tr_b16 a[170:171], v172 offset:256
    ds_read_b64_tr_b16 a[172:173], v172 offset:1024
    ds_read_b64_tr_b16 a[174:175], v172 offset:1280
    ds_read_b128 a[32:35], v164 offset:0
    ds_read_b64_tr_b16 a[192:193], v40 offset:16384
    ds_read_b64_tr_b16 a[194:195], v40 offset:16896
    buffer_load_dwordx4 v4, s[4:7], s64 offen lds
    v_mfma_f32_32x32x16_bf16 v[96:111], a[232:235], a[24:27], v[96:111]
    ds_read_b64_tr_b16 a[196:197], v41 offset:16384
    ds_read_b64_tr_b16 a[198:199], v41 offset:16896
    v_mfma_f32_32x32x16_bf16 v[80:95], a[228:231], a[24:27], v[80:95]
    ds_read_b64_tr_b16 a[200:201], v40 offset:18432
    ds_read_b64_tr_b16 a[202:203], v40 offset:18944
    buffer_load_dwordx4 v5, s[4:7], s64 offen offset:1024 lds
    v_mfma_f32_32x32x16_bf16 v[64:79], a[224:227], a[24:27], v[64:79]
    ds_read_b64_tr_b16 a[204:205], v41 offset:18432
    ds_read_b64_tr_b16 a[206:207], v41 offset:18944
    buffer_load_dwordx4 v6, s[4:7], s64 offen offset:2048 lds
    v_mfma_f32_32x32x16_bf16 v[112:127], a[252:255], a[28:31], v[112:127]
    ds_read_b128 a[36:39], v165 offset:0
    ds_read_b64_tr_b16 a[208:209], v40 offset:20480
    ds_read_b64_tr_b16 a[210:211], v40 offset:20992
    v_mfma_f32_32x32x16_bf16 v[96:111], a[248:251], a[28:31], v[96:111]
    ds_read_b64_tr_b16 a[212:213], v41 offset:20480
    ds_read_b64_tr_b16 a[214:215], v41 offset:20992
    buffer_load_dwordx4 v7, s[4:7], s64 offen offset:3072 lds
    s_add_u32 m0, s59, 0
    v_mfma_f32_32x32x16_bf16 v[80:95], a[244:247], a[28:31], v[80:95]
    ds_read_b64_tr_b16 a[216:217], v40 offset:22528
    ds_read_b64_tr_b16 a[218:219], v40 offset:23040
    buffer_load_dwordx4 v8, s[8:11], s72 offen lds
    v_mfma_f32_32x32x16_bf16 v[64:79], a[240:243], a[28:31], v[64:79]
    ds_read_b64_tr_b16 a[220:221], v41 offset:22528
    ds_read_b64_tr_b16 a[222:223], v41 offset:23040
    s_waitcnt lgkmcnt(9)
    v_mfma_f32_32x32x16_bf16 v[112:127], a[204:207], a[32:35], v[112:127]
    ds_read_b128 a[40:43], v166 offset:0
    ds_read_b64_tr_b16 a[224:225], v40 offset:24576
    ds_read_b64_tr_b16 a[226:227], v40 offset:25088
    buffer_load_dwordx4 v9, s[8:11], s72 offen offset:1024 lds
    s_add_u32 m0, s59, 2048
    v_mfma_f32_32x32x16_bf16 v[96:111], a[200:203], a[32:35], v[96:111]
    ds_read_b64_tr_b16 a[228:229], v41 offset:24576
    ds_read_b64_tr_b16 a[230:231], v41 offset:25088
    buffer_load_dwordx4 v10, s[8:11], s72 offen lds
    v_mfma_f32_32x32x16_bf16 v[80:95], a[196:199], a[32:35], v[80:95]
    ds_read_b64_tr_b16 a[232:233], v40 offset:26624
    ds_read_b64_tr_b16 a[234:235], v40 offset:27136
    v_mfma_f32_32x32x16_bf16 v[64:79], a[192:195], a[32:35], v[64:79]
    ds_read_b64_tr_b16 a[236:237], v41 offset:26624
    ds_read_b64_tr_b16 a[238:239], v41 offset:27136
    buffer_load_dwordx4 v11, s[8:11], s72 offen offset:1024 lds
    s_add_u32 m0, s59, 16384
    s_waitcnt lgkmcnt(9)
    v_mfma_f32_32x32x16_bf16 v[112:127], a[220:223], a[36:39], v[112:127]
    ds_read_b128 a[44:47], v167 offset:0
    ds_read_b64_tr_b16 a[240:241], v40 offset:28672
    ds_read_b64_tr_b16 a[242:243], v40 offset:29184
    buffer_load_dwordx4 v4, s[4:7], s65 offen lds
    v_mfma_f32_32x32x16_bf16 v[96:111], a[216:219], a[36:39], v[96:111]
    ds_read_b64_tr_b16 a[244:245], v41 offset:28672
    ds_read_b64_tr_b16 a[246:247], v41 offset:29184
    v_mfma_f32_32x32x16_bf16 v[80:95], a[212:215], a[36:39], v[80:95]
    ds_read_b64_tr_b16 a[248:249], v40 offset:30720
    ds_read_b64_tr_b16 a[250:251], v40 offset:31232
    buffer_load_dwordx4 v5, s[4:7], s65 offen offset:1024 lds
    v_mfma_f32_32x32x16_bf16 v[64:79], a[208:211], a[36:39], v[64:79]
    ds_read_b64_tr_b16 a[252:253], v41 offset:30720
    ds_read_b64_tr_b16 a[254:255], v41 offset:31232
    buffer_load_dwordx4 v6, s[4:7], s65 offen offset:2048 lds
    s_waitcnt lgkmcnt(9)
    v_mfma_f32_32x32x16_bf16 v[112:127], a[236:239], a[40:43], v[112:127]
    s_waitcnt vmcnt(15)
    s_waitcnt vmcnt(11)
    s_waitcnt lgkmcnt(0)
    s_barrier
    ds_read_b128 a[48:51], v164 offset:32768
    ds_read_b64_tr_b16 a[192:193], v40 offset:49152
    ds_read_b64_tr_b16 a[194:195], v40 offset:49664
    v_mfma_f32_32x32x16_bf16 v[96:111], a[232:235], a[40:43], v[96:111]
    ds_read_b64_tr_b16 a[196:197], v41 offset:49152
    ds_read_b64_tr_b16 a[198:199], v41 offset:49664
    buffer_load_dwordx4 v7, s[4:7], s65 offen offset:3072 lds
    s_add_u32 m0, s59, 32768
    v_mfma_f32_32x32x16_bf16 v[80:95], a[228:231], a[40:43], v[80:95]
    ds_read_b64_tr_b16 a[200:201], v40 offset:51200
    ds_read_b64_tr_b16 a[202:203], v40 offset:51712
    buffer_load_dwordx4 v8, s[8:11], s73 offen lds
    v_mfma_f32_32x32x16_bf16 v[64:79], a[224:227], a[40:43], v[64:79]
    ds_read_b64_tr_b16 a[204:205], v41 offset:51200
    ds_read_b64_tr_b16 a[206:207], v41 offset:51712
    v_mfma_f32_32x32x16_bf16 v[112:127], a[252:255], a[44:47], v[112:127]
    ds_read_b128 a[52:55], v165 offset:32768
    ds_read_b64_tr_b16 a[208:209], v40 offset:53248
    ds_read_b64_tr_b16 a[210:211], v40 offset:53760
    buffer_load_dwordx4 v9, s[8:11], s73 offen offset:1024 lds
    s_add_u32 m0, s59, 34816
    v_mfma_f32_32x32x16_bf16 v[96:111], a[248:251], a[44:47], v[96:111]
    ds_read_b64_tr_b16 a[212:213], v41 offset:53248
    ds_read_b64_tr_b16 a[214:215], v41 offset:53760
    buffer_load_dwordx4 v10, s[8:11], s73 offen lds
    v_mfma_f32_32x32x16_bf16 v[80:95], a[244:247], a[44:47], v[80:95]
    ds_read_b64_tr_b16 a[216:217], v40 offset:55296
    ds_read_b64_tr_b16 a[218:219], v40 offset:55808
    v_mfma_f32_32x32x16_bf16 v[64:79], a[240:243], a[44:47], v[64:79]
    ds_read_b64_tr_b16 a[220:221], v41 offset:55296
    ds_read_b64_tr_b16 a[222:223], v41 offset:55808
    buffer_load_dwordx4 v11, s[8:11], s73 offen offset:1024 lds
    s_add_u32 m0, s59, 49152
    s_waitcnt lgkmcnt(9)
    v_mfma_f32_32x32x16_bf16 v[112:127], a[204:207], a[48:51], v[112:127]
    ds_read_b128 a[56:59], v166 offset:32768
    ds_read_b64_tr_b16 a[224:225], v40 offset:57344
    ds_read_b64_tr_b16 a[226:227], v40 offset:57856
    buffer_load_dwordx4 v4, s[4:7], s66 offen lds
    v_mfma_f32_32x32x16_bf16 v[96:111], a[200:203], a[48:51], v[96:111]
    ds_read_b64_tr_b16 a[228:229], v41 offset:57344
    ds_read_b64_tr_b16 a[230:231], v41 offset:57856
    v_mfma_f32_32x32x16_bf16 v[80:95], a[196:199], a[48:51], v[80:95]
    ds_read_b64_tr_b16 a[232:233], v40 offset:59392
    ds_read_b64_tr_b16 a[234:235], v40 offset:59904
    buffer_load_dwordx4 v5, s[4:7], s66 offen offset:1024 lds
    v_mfma_f32_32x32x16_bf16 v[64:79], a[192:195], a[48:51], v[64:79]
    ds_read_b64_tr_b16 a[236:237], v41 offset:59392
    ds_read_b64_tr_b16 a[238:239], v41 offset:59904
    buffer_load_dwordx4 v6, s[4:7], s66 offen offset:2048 lds
    s_waitcnt lgkmcnt(9)
    v_mfma_f32_32x32x16_bf16 v[112:127], a[220:223], a[52:55], v[112:127]
    ds_read_b128 a[60:63], v167 offset:32768
    ds_read_b64_tr_b16 a[240:241], v40 offset:61440
    ds_read_b64_tr_b16 a[242:243], v40 offset:61952
    v_mfma_f32_32x32x16_bf16 v[96:111], a[216:219], a[52:55], v[96:111]
    ds_read_b64_tr_b16 a[244:245], v41 offset:61440
    ds_read_b64_tr_b16 a[246:247], v41 offset:61952
    buffer_load_dwordx4 v7, s[4:7], s66 offen offset:3072 lds
    s_add_u32 m0, s59, 65536
    v_mfma_f32_32x32x16_bf16 v[80:95], a[212:215], a[52:55], v[80:95]
    ds_read_b64_tr_b16 a[248:249], v40 offset:63488
    ds_read_b64_tr_b16 a[250:251], v40 offset:64000
    buffer_load_dwordx4 v8, s[8:11], s74 offen lds
    v_mfma_f32_32x32x16_bf16 v[64:79], a[208:211], a[52:55], v[64:79]
    ds_read_b64_tr_b16 a[252:253], v41 offset:63488
    ds_read_b64_tr_b16 a[254:255], v41 offset:64000
    s_waitcnt lgkmcnt(9)
    v_mfma_f32_32x32x16_bf16 v[112:127], a[236:239], a[56:59], v[112:127]
    s_waitcnt vmcnt(17)
    s_waitcnt vmcnt(13)
    s_waitcnt lgkmcnt(0)
    s_barrier
    ds_read_b128 a[64:67], v168 offset:0
    ds_read_b64_tr_b16 a[192:193], v38 offset:0
    ds_read_b64_tr_b16 a[194:195], v38 offset:512
    buffer_load_dwordx4 v9, s[8:11], s74 offen offset:1024 lds
    s_add_u32 m0, s59, 67584
    v_mfma_f32_32x32x16_bf16 v[96:111], a[232:235], a[56:59], v[96:111]
    ds_read_b64_tr_b16 a[196:197], v39 offset:0
    ds_read_b64_tr_b16 a[198:199], v39 offset:512
    buffer_load_dwordx4 v10, s[8:11], s74 offen lds
    v_mfma_f32_32x32x16_bf16 v[80:95], a[228:231], a[56:59], v[80:95]
    ds_read_b64_tr_b16 a[200:201], v38 offset:2048
    ds_read_b64_tr_b16 a[202:203], v38 offset:2560
    v_mfma_f32_32x32x16_bf16 v[64:79], a[224:227], a[56:59], v[64:79]
    ds_read_b64_tr_b16 a[204:205], v39 offset:2048
    ds_read_b64_tr_b16 a[206:207], v39 offset:2560
    buffer_load_dwordx4 v11, s[8:11], s74 offen offset:1024 lds
    s_add_u32 m0, s59, 81920
    v_mfma_f32_32x32x16_bf16 v[112:127], a[252:255], a[60:63], v[112:127]
    ds_read_b128 a[68:71], v169 offset:0
    ds_read_b64_tr_b16 a[208:209], v38 offset:4096
    ds_read_b64_tr_b16 a[210:211], v38 offset:4608
    buffer_load_dwordx4 v4, s[4:7], s67 offen lds
    v_mfma_f32_32x32x16_bf16 v[96:111], a[248:251], a[60:63], v[96:111]
    ds_read_b64_tr_b16 a[212:213], v39 offset:4096
    ds_read_b64_tr_b16 a[214:215], v39 offset:4608
    v_mfma_f32_32x32x16_bf16 v[80:95], a[244:247], a[60:63], v[80:95]
    ds_read_b64_tr_b16 a[216:217], v38 offset:6144
    ds_read_b64_tr_b16 a[218:219], v38 offset:6656
    buffer_load_dwordx4 v5, s[4:7], s67 offen offset:1024 lds
    v_mfma_f32_32x32x16_bf16 v[64:79], a[240:243], a[60:63], v[64:79]
    ds_read_b64_tr_b16 a[220:221], v39 offset:6144
    ds_read_b64_tr_b16 a[222:223], v39 offset:6656
    buffer_load_dwordx4 v6, s[4:7], s67 offen offset:2048 lds
    s_waitcnt lgkmcnt(9)
    v_mfma_f32_32x32x16_bf16 v[112:127], a[204:207], a[64:67], v[112:127]
    ds_read_b128 a[72:75], v170 offset:0
    ds_read_b64_tr_b16 a[224:225], v38 offset:8192
    ds_read_b64_tr_b16 a[226:227], v38 offset:8704
    v_mfma_f32_32x32x16_bf16 v[96:111], a[200:203], a[64:67], v[96:111]
    ds_read_b64_tr_b16 a[228:229], v39 offset:8192
    ds_read_b64_tr_b16 a[230:231], v39 offset:8704
    buffer_load_dwordx4 v7, s[4:7], s67 offen offset:3072 lds
    s_add_u32 m0, s59, 98304
    v_mfma_f32_32x32x16_bf16 v[80:95], a[196:199], a[64:67], v[80:95]
    ds_read_b64_tr_b16 a[232:233], v38 offset:10240
    ds_read_b64_tr_b16 a[234:235], v38 offset:10752
    buffer_load_dwordx4 v8, s[8:11], s75 offen lds
    v_mfma_f32_32x32x16_bf16 v[64:79], a[192:195], a[64:67], v[64:79]
    ds_read_b64_tr_b16 a[236:237], v39 offset:10240
    ds_read_b64_tr_b16 a[238:239], v39 offset:10752
    s_waitcnt lgkmcnt(9)
    v_mfma_f32_32x32x16_bf16 v[112:127], a[220:223], a[68:71], v[112:127]
    ds_read_b128 a[76:79], v171 offset:0
    ds_read_b64_tr_b16 a[240:241], v38 offset:12288
    ds_read_b64_tr_b16 a[242:243], v38 offset:12800
    buffer_load_dwordx4 v9, s[8:11], s75 offen offset:1024 lds
    s_add_u32 m0, s59, 100352
    v_mfma_f32_32x32x16_bf16 v[96:111], a[216:219], a[68:71], v[96:111]
    ds_read_b64_tr_b16 a[244:245], v39 offset:12288
    ds_read_b64_tr_b16 a[246:247], v39 offset:12800
    buffer_load_dwordx4 v10, s[8:11], s75 offen lds
    v_mfma_f32_32x32x16_bf16 v[80:95], a[212:215], a[68:71], v[80:95]
    ds_read_b64_tr_b16 a[248:249], v38 offset:14336
    ds_read_b64_tr_b16 a[250:251], v38 offset:14848
    v_mfma_f32_32x32x16_bf16 v[64:79], a[208:211], a[68:71], v[64:79]
    ds_read_b64_tr_b16 a[252:253], v39 offset:14336
    ds_read_b64_tr_b16 a[254:255], v39 offset:14848
    buffer_load_dwordx4 v11, s[8:11], s75 offen offset:1024 lds
    s_add_u32 m0, s58, 114688
    s_waitcnt lgkmcnt(9)
    v_mfma_f32_32x32x16_bf16 v[112:127], a[236:239], a[72:75], v[112:127]
    s_waitcnt vmcnt(20)
    s_waitcnt vmcnt(16)
    s_waitcnt lgkmcnt(0)
    s_barrier
    ds_read_b128 a[80:83], v160 offset:16384
    ds_read_b64_tr_b16 a[192:193], v38 offset:32768
    ds_read_b64_tr_b16 a[194:195], v38 offset:33280
    buffer_load_dwordx4 v12, s[12:15], s76 offen lds
    v_mfma_f32_32x32x16_bf16 v[96:111], a[232:235], a[72:75], v[96:111]
    ds_read_b64_tr_b16 a[196:197], v39 offset:32768
    ds_read_b64_tr_b16 a[198:199], v39 offset:33280
    v_mfma_f32_32x32x16_bf16 v[80:95], a[228:231], a[72:75], v[80:95]
    ds_read_b64_tr_b16 a[200:201], v38 offset:34816
    ds_read_b64_tr_b16 a[202:203], v38 offset:35328
    buffer_load_dwordx4 v13, s[12:15], s76 offen offset:1024 lds
    s_add_u32 m0, s58, 122880
    v_mfma_f32_32x32x16_bf16 v[64:79], a[224:227], a[72:75], v[64:79]
    ds_read_b64_tr_b16 a[204:205], v39 offset:34816
    ds_read_b64_tr_b16 a[206:207], v39 offset:35328
    buffer_load_dwordx4 v12, s[12:15], s77 offen lds
    v_mfma_f32_32x32x16_bf16 v[112:127], a[252:255], a[76:79], v[112:127]
    ds_read_b128 a[84:87], v161 offset:16384
    ds_read_b64_tr_b16 a[208:209], v38 offset:36864
    ds_read_b64_tr_b16 a[210:211], v38 offset:37376
    v_mfma_f32_32x32x16_bf16 v[96:111], a[248:251], a[76:79], v[96:111]
    ds_read_b64_tr_b16 a[212:213], v39 offset:36864
    ds_read_b64_tr_b16 a[214:215], v39 offset:37376
    buffer_load_dwordx4 v13, s[12:15], s77 offen offset:1024 lds
    v_mfma_f32_32x32x16_bf16 v[80:95], a[244:247], a[76:79], v[80:95]
    ds_read_b64_tr_b16 a[216:217], v38 offset:38912
    ds_read_b64_tr_b16 a[218:219], v38 offset:39424
    v_mfma_f32_32x32x16_bf16 v[64:79], a[240:243], a[76:79], v[64:79]
    ds_read_b64_tr_b16 a[220:221], v39 offset:38912
    ds_read_b64_tr_b16 a[222:223], v39 offset:39424
    s_waitcnt lgkmcnt(9)
    v_mfma_f32_32x32x16_bf16 v[112:127], a[204:207], a[80:83], v[112:127]
    ds_read_b128 a[88:91], v162 offset:16384
    ds_read_b64_tr_b16 a[224:225], v38 offset:40960
    ds_read_b64_tr_b16 a[226:227], v38 offset:41472
    v_mfma_f32_32x32x16_bf16 v[96:111], a[200:203], a[80:83], v[96:111]
    ds_read_b64_tr_b16 a[228:229], v39 offset:40960
    ds_read_b64_tr_b16 a[230:231], v39 offset:41472
    v_mov_b32 v4, v61
    s_lshl2_add_u32 s47, s2, s50
    s_mul_i32 s47, s47, 1792
    v_lshlrev_b32 v152, 7, v0
    s_mov_b64 exec, 0x3fff
    buffer_load_dword v156, v152, s[16:19], s47 offen
    s_mov_b64 exec, -1
    v_mfma_f32_32x32x16_bf16 v[80:95], a[196:199], a[80:83], v[80:95]
    ds_read_b64_tr_b16 a[232:233], v38 offset:43008
    ds_read_b64_tr_b16 a[234:235], v38 offset:43520
    s_lshl2_add_u32 s47, s2, s50
    s_mul_i32 s47, s47, 512
    v_lshlrev_b32 v152, 7, v0
    s_mov_b64 exec, 0xf
    buffer_load_dword v157, v152, s[20:23], s47 offen
    s_mov_b64 exec, -1
    v_mfma_f32_32x32x16_bf16 v[64:79], a[192:195], a[80:83], v[64:79]
    ds_read_b64_tr_b16 a[236:237], v39 offset:43008
    ds_read_b64_tr_b16 a[238:239], v39 offset:43520
    v_mov_b32 v7, v59
    s_waitcnt lgkmcnt(9)
    v_mfma_f32_32x32x16_bf16 v[112:127], a[220:223], a[84:87], v[112:127]
    ds_read_b128 a[92:95], v163 offset:16384
    ds_read_b64_tr_b16 a[240:241], v38 offset:45056
    ds_read_b64_tr_b16 a[242:243], v38 offset:45568
    v_add_u32 v5, s53, v61
    v_mfma_f32_32x32x16_bf16 v[96:111], a[216:219], a[84:87], v[96:111]
    ds_read_b64_tr_b16 a[244:245], v39 offset:45056
    ds_read_b64_tr_b16 a[246:247], v39 offset:45568
    v_and_b32 v6, 0x33, v0
    v_mfma_f32_32x32x16_bf16 v[80:95], a[212:215], a[84:87], v[80:95]
    ds_read_b64_tr_b16 a[248:249], v38 offset:47104
    ds_read_b64_tr_b16 a[250:251], v38 offset:47616
    v_mfma_f32_32x32x16_bf16 v[64:79], a[208:211], a[84:87], v[64:79]
    ds_read_b64_tr_b16 a[252:253], v39 offset:47104
    ds_read_b64_tr_b16 a[254:255], v39 offset:47616
    v_and_b32 v2, 4, v0
    s_waitcnt lgkmcnt(9)
    v_mfma_f32_32x32x16_bf16 v[112:127], a[236:239], a[88:91], v[112:127]
    s_waitcnt vmcnt(18)
    s_waitcnt vmcnt(14)
    s_waitcnt lgkmcnt(0)
    s_barrier
    ds_read_b128 a[96:99], v160 offset:49152
    ds_read_b64_tr_b16 a[192:193], v40 offset:0
    ds_read_b64_tr_b16 a[194:195], v40 offset:512
    v_lshl_or_b32 v6, v2, 1, v6
    v_mfma_f32_32x32x16_bf16 v[96:111], a[232:235], a[88:91], v[96:111]
    ds_read_b64_tr_b16 a[196:197], v41 offset:0
    ds_read_b64_tr_b16 a[198:199], v41 offset:512
    v_mfma_f32_32x32x16_bf16 v[80:95], a[228:231], a[88:91], v[80:95]
    ds_read_b64_tr_b16 a[200:201], v40 offset:2048
    ds_read_b64_tr_b16 a[202:203], v40 offset:2560
    v_bfe_u32 v2, v0, 3, 1
    v_mfma_f32_32x32x16_bf16 v[64:79], a[224:227], a[88:91], v[64:79]
    ds_read_b64_tr_b16 a[204:205], v41 offset:2048
    ds_read_b64_tr_b16 a[206:207], v41 offset:2560
    v_lshl_or_b32 v6, v2, 2, v6
    v_mfma_f32_32x32x16_bf16 v[112:127], a[252:255], a[92:95], v[112:127]
    ds_read_b128 a[100:103], v161 offset:49152
    ds_read_b64_tr_b16 a[208:209], v40 offset:4096
    ds_read_b64_tr_b16 a[210:211], v40 offset:4608
    v_mfma_f32_32x32x16_bf16 v[96:111], a[248:251], a[92:95], v[96:111]
    ds_read_b64_tr_b16 a[212:213], v41 offset:4096
    ds_read_b64_tr_b16 a[214:215], v41 offset:4608
    v_and_b32 v3, 31, v6
    v_mfma_f32_32x32x16_bf16 v[80:95], a[244:247], a[92:95], v[80:95]
    ds_read_b64_tr_b16 a[216:217], v40 offset:6144
    ds_read_b64_tr_b16 a[218:219], v40 offset:6656
    s_lshl_b32 s49, s46, 7
    v_mfma_f32_32x32x16_bf16 v[64:79], a[240:243], a[92:95], v[64:79]
    ds_read_b64_tr_b16 a[220:221], v41 offset:6144
    ds_read_b64_tr_b16 a[222:223], v41 offset:6656
    s_add_u32 s49, s49, 65536
    s_waitcnt lgkmcnt(9)
    v_mfma_f32_32x32x16_bf16 v[112:127], a[204:207], a[96:99], v[112:127]
    ds_read_b128 a[104:107], v162 offset:49152
    ds_read_b64_tr_b16 a[224:225], v40 offset:8192
    ds_read_b64_tr_b16 a[226:227], v40 offset:8704
    buffer_load_dword v62, off, s[32:35], 0 sc1
    v_mfma_f32_32x32x16_bf16 v[96:111], a[200:203], a[96:99], v[96:111]
    ds_read_b64_tr_b16 a[228:229], v41 offset:8192
    ds_read_b64_tr_b16 a[230:231], v41 offset:8704
    v_lshl_add_u32 v3, v3, 2, s49
    v_mfma_f32_32x32x16_bf16 v[80:95], a[196:199], a[96:99], v[80:95]
    ds_read_b64_tr_b16 a[232:233], v40 offset:10240
    ds_read_b64_tr_b16 a[234:235], v40 offset:10752
    s_lshl_b32 s49, s46, 10
    v_mfma_f32_32x32x16_bf16 v[64:79], a[192:195], a[96:99], v[64:79]
    ds_read_b64_tr_b16 a[236:237], v41 offset:10240
    ds_read_b64_tr_b16 a[238:239], v41 offset:10752
    s_waitcnt lgkmcnt(9)
    v_mfma_f32_32x32x16_bf16 v[112:127], a[220:223], a[100:103], v[112:127]
    ds_read_b128 a[108:111], v163 offset:49152
    ds_read_b64_tr_b16 a[240:241], v40 offset:12288
    ds_read_b64_tr_b16 a[242:243], v40 offset:12800
    s_add_u32 s49, s49, 131072
    v_mfma_f32_32x32x16_bf16 v[96:111], a[216:219], a[100:103], v[96:111]
    ds_read_b64_tr_b16 a[244:245], v41 offset:12288
    ds_read_b64_tr_b16 a[246:247], v41 offset:12800
    v_lshl_add_u32 v6, v6, 4, s49
    v_mfma_f32_32x32x16_bf16 v[80:95], a[212:215], a[100:103], v[80:95]
    ds_read_b64_tr_b16 a[248:249], v40 offset:14336
    ds_read_b64_tr_b16 a[250:251], v40 offset:14848
    v_and_b32 v2, 31, v0
    v_mfma_f32_32x32x16_bf16 v[64:79], a[208:211], a[100:103], v[64:79]
    ds_read_b64_tr_b16 a[252:253], v41 offset:14336
    ds_read_b64_tr_b16 a[254:255], v41 offset:14848
    s_waitcnt lgkmcnt(9)
    v_mfma_f32_32x32x16_bf16 v[112:127], a[236:239], a[104:107], v[112:127]
    s_waitcnt vmcnt(11)
    s_waitcnt vmcnt(7)
    s_waitcnt lgkmcnt(0)
    s_barrier
    ds_read_b128 a[112:115], v164 offset:16384
    ds_read_b64_tr_b16 a[192:193], v40 offset:32768
    ds_read_b64_tr_b16 a[194:195], v40 offset:33280
    v_lshl_add_u32 v2, s50, 5, v2
    s_add_u32 m0, s58, 0
    v_mfma_f32_32x32x16_bf16 v[96:111], a[232:235], a[104:107], v[96:111]
    ds_read_b64_tr_b16 a[196:197], v41 offset:32768
    ds_read_b64_tr_b16 a[198:199], v41 offset:33280
    buffer_load_dwordx4 v12, s[12:15], s78 offen lds
    v_lshlrev_b32 v8, 5, v2
    v_mfma_f32_32x32x16_bf16 v[80:95], a[228:231], a[104:107], v[80:95]
    ds_read_b64_tr_b16 a[200:201], v40 offset:34816
    ds_read_b64_tr_b16 a[202:203], v40 offset:35328
    v_mfma_f32_32x32x16_bf16 v[64:79], a[224:227], a[104:107], v[64:79]
    ds_read_b64_tr_b16 a[204:205], v41 offset:34816
    ds_read_b64_tr_b16 a[206:207], v41 offset:35328
    buffer_load_dwordx4 v13, s[12:15], s78 offen offset:1024 lds
    v_lshl_add_u32 v8, v208, 4, v8
    v_mfma_f32_32x32x16_bf16 v[112:127], a[252:255], a[108:111], v[112:127]
    ds_read_b128 a[116:119], v165 offset:16384
    ds_read_b64_tr_b16 a[208:209], v40 offset:36864
    ds_read_b64_tr_b16 a[210:211], v40 offset:37376
    v_add_u32 v9, 0x10000, v8
    s_add_u32 m0, s58, 8192
    v_mfma_f32_32x32x16_bf16 v[96:111], a[248:251], a[108:111], v[96:111]
    ds_read_b64_tr_b16 a[212:213], v41 offset:36864
    ds_read_b64_tr_b16 a[214:215], v41 offset:37376
    buffer_load_dwordx4 v12, s[12:15], s79 offen lds
    v_mfma_f32_32x32x16_bf16 v[80:95], a[244:247], a[108:111], v[80:95]
    ds_read_b64_tr_b16 a[216:217], v40 offset:38912
    ds_read_b64_tr_b16 a[218:219], v40 offset:39424
    v_add_u32 v10, 0x20000, v8
    v_mfma_f32_32x32x16_bf16 v[64:79], a[240:243], a[108:111], v[64:79]
    ds_read_b64_tr_b16 a[220:221], v41 offset:38912
    ds_read_b64_tr_b16 a[222:223], v41 offset:39424
    s_mov_b32 s48, 16384
    buffer_load_dwordx4 v13, s[12:15], s79 offen offset:1024 lds
    s_waitcnt lgkmcnt(9)
    v_mfma_f32_32x32x16_bf16 v[112:127], a[204:207], a[112:115], v[112:127]
    ds_read_b128 a[120:123], v166 offset:16384
    ds_read_b64_tr_b16 a[224:225], v40 offset:40960
    ds_read_b64_tr_b16 a[226:227], v40 offset:41472
    s_mov_b32 s49, 32768
    s_add_u32 m0, s58, 49152
    v_mfma_f32_32x32x16_bf16 v[96:111], a[200:203], a[112:115], v[96:111]
    ds_read_b64_tr_b16 a[228:229], v41 offset:40960
    ds_read_b64_tr_b16 a[230:231], v41 offset:41472
    buffer_load_dwordx4 v12, s[12:15], s80 offen lds
    v_mfma_f32_32x32x16_bf16 v[80:95], a[196:199], a[112:115], v[80:95]
    ds_read_b64_tr_b16 a[232:233], v40 offset:43008
    ds_read_b64_tr_b16 a[234:235], v40 offset:43520
    v_mfma_f32_32x32x16_bf16 v[64:79], a[192:195], a[112:115], v[64:79]
    ds_read_b64_tr_b16 a[236:237], v41 offset:43008
    ds_read_b64_tr_b16 a[238:239], v41 offset:43520
    s_cmp_lt_u32 s50, 2
    s_cselect_b32 s48, s48, s49
    buffer_load_dwordx4 v13, s[12:15], s80 offen offset:1024 lds
    s_waitcnt lgkmcnt(9)
    v_mfma_f32_32x32x16_bf16 v[112:127], a[220:223], a[116:119], v[112:127]
    ds_read_b128 a[124:127], v167 offset:16384
    ds_read_b64_tr_b16 a[240:241], v40 offset:45056
    ds_read_b64_tr_b16 a[242:243], v40 offset:45568
    s_add_u32 m0, s58, 57344
    v_mfma_f32_32x32x16_bf16 v[96:111], a[216:219], a[116:119], v[96:111]
    ds_read_b64_tr_b16 a[244:245], v41 offset:45056
    ds_read_b64_tr_b16 a[246:247], v41 offset:45568
    s_and_b32 s49, s50, 1
    buffer_load_dwordx4 v12, s[12:15], s81 offen lds
    v_mfma_f32_32x32x16_bf16 v[80:95], a[212:215], a[116:119], v[80:95]
    ds_read_b64_tr_b16 a[248:249], v40 offset:47104
    ds_read_b64_tr_b16 a[250:251], v40 offset:47616
    s_lshl_b32 s49, s49, 13
    v_mfma_f32_32x32x16_bf16 v[64:79], a[208:211], a[116:119], v[64:79]
    ds_read_b64_tr_b16 a[252:253], v41 offset:47104
    ds_read_b64_tr_b16 a[254:255], v41 offset:47616
    buffer_load_dwordx4 v13, s[12:15], s81 offen offset:1024 lds
    s_waitcnt lgkmcnt(9)
    v_mfma_f32_32x32x16_bf16 v[112:127], a[236:239], a[120:123], v[112:127]
    s_waitcnt vmcnt(11)
    s_waitcnt lgkmcnt(0)
    s_barrier
    ds_read_b64_tr_b16 a[128:129], v40 offset:49152
    ds_read_b64_tr_b16 a[130:131], v40 offset:49664
    s_add_u32 s48, s48, s49
    s_add_u32 m0, s58, 65536
    v_mfma_f32_32x32x16_bf16 v[96:111], a[232:235], a[120:123], v[96:111]
    ds_read_b64_tr_b16 a[132:133], v41 offset:49152
    ds_read_b64_tr_b16 a[134:135], v41 offset:49664
    buffer_load_dwordx4 v12, s[12:15], s82 offen lds
    v_lshl_add_u32 v11, v0, 3, s48
    v_mfma_f32_32x32x16_bf16 v[80:95], a[228:231], a[120:123], v[80:95]
    s_add_u32 s49, s59, 131072
    v_mfma_f32_32x32x16_bf16 v[64:79], a[224:227], a[120:123], v[64:79]
    buffer_load_dwordx4 v13, s[12:15], s82 offen offset:1024 lds
    v_mfma_f32_32x32x16_bf16 v[112:127], a[252:255], a[124:127], v[112:127]
    ds_read_b64_tr_b16 a[136:137], v40 offset:51200
    ds_read_b64_tr_b16 a[138:139], v40 offset:51712
    v_lshl_add_u32 v58, v0, 3, s49
    s_add_u32 m0, s58, 73728
    v_mfma_f32_32x32x16_bf16 v[96:111], a[248:251], a[124:127], v[96:111]
    ds_read_b64_tr_b16 a[140:141], v41 offset:51200
    ds_read_b64_tr_b16 a[142:143], v41 offset:51712
    buffer_load_dwordx4 v12, s[12:15], s83 offen lds
    v_mfma_f32_32x32x16_bf16 v[80:95], a[244:247], a[124:127], v[80:95]
    v_mfma_f32_32x32x16_bf16 v[64:79], a[240:243], a[124:127], v[64:79]
    buffer_load_dwordx4 v13, s[12:15], s83 offen offset:1024 lds
    s_waitcnt lgkmcnt(4)
    v_mfma_f32_32x32x16_bf16 v[176:191], a[132:135], a[0:3], 0
    ds_read_b64_tr_b16 a[144:145], v40 offset:53248
    ds_read_b64_tr_b16 a[146:147], v40 offset:53760
    s_add_u32 m0, s59, 81920
    v_mfma_f32_32x32x16_bf16 v[160:175], a[128:131], a[0:3], 0
    ds_read_b64_tr_b16 a[148:149], v41 offset:53248
    ds_read_b64_tr_b16 a[150:151], v41 offset:53760
    buffer_load_dwordx4 v14, s[12:15], s100 offen lds
    s_nop 1
    v_cvt_pk_bf16_f32 v224, v64, v65
    v_cvt_pk_bf16_f32 v225, v66, v67
    v_cvt_pk_bf16_f32 v226, v68, v69
    v_cvt_pk_bf16_f32 v227, v70, v71
    v_cvt_pk_bf16_f32 v228, v72, v73
    v_cvt_pk_bf16_f32 v229, v74, v75
    v_cvt_pk_bf16_f32 v230, v76, v77
    v_cvt_pk_bf16_f32 v231, v78, v79
    v_cvt_pk_bf16_f32 v232, v80, v81
    v_cvt_pk_bf16_f32 v233, v82, v83
    v_cvt_pk_bf16_f32 v234, v84, v85
    v_cvt_pk_bf16_f32 v235, v86, v87
    v_cvt_pk_bf16_f32 v236, v88, v89
    v_cvt_pk_bf16_f32 v237, v90, v91
    v_cvt_pk_bf16_f32 v238, v92, v93
    v_cvt_pk_bf16_f32 v239, v94, v95
    v_mfma_f32_32x32x16_bf16 v[192:207], a[168:171], v[224:227], 0
    s_waitcnt lgkmcnt(4)
    v_mfma_f32_32x32x16_bf16 v[176:191], a[140:143], a[4:7], v[176:191]
    ds_read_b64_tr_b16 a[152:153], v40 offset:55296
    ds_read_b64_tr_b16 a[154:155], v40 offset:55808
    v_mfma_f32_32x32x16_bf16 v[208:223], a[168:171], v[228:231], 0
    v_mfma_f32_32x32x16_bf16 v[64:79], a[172:175], v[232:235], 0
    v_mfma_f32_32x32x16_bf16 v[160:175], a[136:139], a[4:7], v[160:175]
    ds_read_b64_tr_b16 a[156:157], v41 offset:55296
    ds_read_b64_tr_b16 a[158:159], v41 offset:55808
    buffer_load_dwordx4 v15, s[12:15], s100 offen offset:1024 lds
    v_mfma_f32_32x32x16_bf16 v[80:95], a[172:175], v[236:239], 0
    v_cvt_pk_bf16_f32 v96, v96, v97
    v_cvt_pk_bf16_f32 v97, v98, v99
    v_cvt_pk_bf16_f32 v98, v100, v101
    v_cvt_pk_bf16_f32 v99, v102, v103
    s_waitcnt lgkmcnt(4)
    v_mfma_f32_32x32x16_bf16 v[176:191], a[148:151], a[8:11], v[176:191]
    ds_read_b64_tr_b16 a[128:129], v40 offset:57344
    ds_read_b64_tr_b16 a[130:131], v40 offset:57856
    ds_write_b128 v10, v[96:99] offset:0
    v_cvt_pk_bf16_f32 v104, v104, v105
    v_cvt_pk_bf16_f32 v105, v106, v107
    v_cvt_pk_bf16_f32 v106, v108, v109
    v_cvt_pk_bf16_f32 v107, v110, v111
    v_mfma_f32_32x32x16_bf16 v[160:175], a[144:147], a[8:11], v[160:175]
    ds_read_b64_tr_b16 a[132:133], v41 offset:57344
    ds_read_b64_tr_b16 a[134:135], v41 offset:57856
    buffer_load_dwordx4 v16, s[12:15], s100 offen offset:2048 lds
    ds_write_b128 v10, v[104:107] offset:4096
    v_cvt_pk_bf16_f32 v112, v112, v113
    v_cvt_pk_bf16_f32 v113, v114, v115
    v_cvt_pk_bf16_f32 v114, v116, v117
    v_cvt_pk_bf16_f32 v115, v118, v119
    s_waitcnt lgkmcnt(6)
    v_mfma_f32_32x32x16_bf16 v[176:191], a[156:159], a[12:15], v[176:191]
    ds_read_b64_tr_b16 a[136:137], v40 offset:59392
    ds_read_b64_tr_b16 a[138:139], v40 offset:59904
    ds_write_b128 v10, v[112:115] offset:8192
    v_cvt_pk_bf16_f32 v120, v120, v121
    v_cvt_pk_bf16_f32 v121, v122, v123
    v_cvt_pk_bf16_f32 v122, v124, v125
    v_cvt_pk_bf16_f32 v123, v126, v127
    v_mfma_f32_32x32x16_bf16 v[160:175], a[152:155], a[12:15], v[160:175]
    ds_read_b64_tr_b16 a[140:141], v41 offset:59392
    ds_read_b64_tr_b16 a[142:143], v41 offset:59904
    buffer_load_dwordx4 v17, s[12:15], s100 offen offset:3072 lds
    ds_write_b128 v10, v[120:123] offset:12288
    v_max3_f32 v240, v192, v193, v194
    v_max3_f32 v241, v216, v217, v218
    v_min3_f32 v242, v192, v193, v194
    v_min3_f32 v243, v216, v217, v218
    v_max3_f32 v240, v240, v195, v196
    v_max3_f32 v241, v241, v219, v220
    v_min3_f32 v242, v242, v195, v196
    v_min3_f32 v243, v243, v219, v220
    v_max3_f32 v240, v240, v197, v198
    v_max3_f32 v241, v241, v221, v222
    v_min3_f32 v242, v242, v197, v198
    v_min3_f32 v243, v243, v221, v222
    v_max_f32 v240, v240, v199
    v_max_f32 v241, v241, v223
    v_min_f32 v242, v242, v199
    v_min_f32 v243, v243, v223
    v_permlane32_swap_b32 v240, v241
    s_nop 0
    v_permlane32_swap_b32 v242, v243
    v_max_f32 v240, v240, v241
    v_min_f32 v242, v242, v243
    v_mul_f32 v241, s51, v240
    v_mul_f32 v240, s51, v240
    v_mul_f32 v243, s51, v242
    v_mul_f32 v242, s51, v242
    v_permlane32_swap_b32 v240, v241
    s_nop 0
    v_permlane32_swap_b32 v242, v243
    v_fma_f32 v200, v192, -s51, v242
    v_fma_f32 v201, v193, -s51, v242
    v_fma_f32 v202, v194, -s51, v242
    v_fma_f32 v203, v195, -s51, v242
    v_fma_f32 v192, v192, s51, -v240
    v_fma_f32 v193, v193, s51, -v240
    v_fma_f32 v194, v194, s51, -v240
    v_fma_f32 v195, v195, s51, -v240
    v_exp_f32 v200, v200
    v_exp_f32 v201, v201
    v_exp_f32 v202, v202
    v_exp_f32 v203, v203
    v_exp_f32 v192, v192
    v_exp_f32 v193, v193
    v_exp_f32 v194, v194
    v_exp_f32 v195, v195
    v_fma_f32 v204, v196, -s51, v242
    v_fma_f32 v205, v197, -s51, v242
    v_fma_f32 v206, v198, -s51, v242
    v_fma_f32 v207, v199, -s51, v242
    v_fma_f32 v196, v196, s51, -v240
    v_fma_f32 v197, v197, s51, -v240
    s_waitcnt lgkmcnt(7)
    v_mfma_f32_32x32x16_bf16 v[176:191], a[132:135], a[16:19], v[176:191]
    ds_read_b64_tr_b16 a[144:145], v40 offset:61440
    ds_read_b64_tr_b16 a[146:147], v40 offset:61952
    v_fma_f32 v198, v198, s51, -v240
    v_fma_f32 v199, v199, s51, -v240
    v_exp_f32 v204, v204
    v_exp_f32 v205, v205
    v_exp_f32 v206, v206
    v_exp_f32 v207, v207
    v_exp_f32 v196, v196
    v_exp_f32 v197, v197
    v_exp_f32 v198, v198
    v_exp_f32 v199, v199
    v_fma_f32 v208, v216, -s51, v243
    v_fma_f32 v209, v217, -s51, v243
    v_fma_f32 v210, v218, -s51, v243
    s_add_u32 m0, s59, 98304
    v_mfma_f32_32x32x16_bf16 v[160:175], a[128:131], a[16:19], v[160:175]
    ds_read_b64_tr_b16 a[148:149], v41 offset:61440
    ds_read_b64_tr_b16 a[150:151], v41 offset:61952
    buffer_load_dwordx4 v14, s[12:15], s101 offen lds
    v_fma_f32 v211, v219, -s51, v243
    v_fma_f32 v216, v216, s51, -v241
    v_fma_f32 v217, v217, s51, -v241
    v_fma_f32 v218, v218, s51, -v241
    v_fma_f32 v219, v219, s51, -v241
    v_exp_f32 v208, v208
    v_exp_f32 v209, v209
    v_exp_f32 v210, v210
    v_exp_f32 v211, v211
    v_exp_f32 v216, v216
    v_exp_f32 v217, v217
    v_exp_f32 v218, v218
    v_exp_f32 v219, v219
    v_fma_f32 v212, v220, -s51, v243
    s_waitcnt lgkmcnt(5)
    v_mfma_f32_32x32x16_bf16 v[176:191], a[140:143], a[20:23], v[176:191]
    ds_read_b64_tr_b16 a[152:153], v40 offset:63488
    ds_read_b64_tr_b16 a[154:155], v40 offset:64000
    v_fma_f32 v213, v221, -s51, v243
    v_fma_f32 v214, v222, -s51, v243
    v_fma_f32 v215, v223, -s51, v243
    v_fma_f32 v220, v220, s51, -v241
    v_fma_f32 v221, v221, s51, -v241
    v_fma_f32 v222, v222, s51, -v241
    v_fma_f32 v223, v223, s51, -v241
    v_exp_f32 v212, v212
    v_exp_f32 v213, v213
    v_exp_f32 v214, v214
    v_exp_f32 v215, v215
    v_exp_f32 v220, v220
    v_exp_f32 v221, v221
    v_exp_f32 v222, v222
    v_mfma_f32_32x32x16_bf16 v[160:175], a[136:139], a[20:23], v[160:175]
    ds_read_b64_tr_b16 a[156:157], v41 offset:63488
    ds_read_b64_tr_b16 a[158:159], v41 offset:64000
    buffer_load_dwordx4 v15, s[12:15], s101 offen offset:1024 lds
    v_exp_f32 v223, v223
    v_add_f32 v240, v192, v193
    v_add_f32 v241, v216, v217
    v_add_f32 v242, v200, v201
    v_add_f32 v243, v208, v209
    v_add_f32 v240, v240, v194
    v_add_f32 v241, v241, v218
    v_add_f32 v242, v242, v202
    v_add_f32 v243, v243, v210
    v_add_f32 v240, v240, v195
    v_add_f32 v241, v241, v219
    v_add_f32 v242, v242, v203
    v_add_f32 v243, v243, v211
    v_add_f32 v240, v240, v196
    v_add_f32 v241, v241, v220
    v_add_f32 v242, v242, v204
    v_add_f32 v243, v243, v212
    v_add_f32 v240, v240, v197
    v_add_f32 v241, v241, v221
    v_add_f32 v242, v242, v205
    s_waitcnt lgkmcnt(4)
    v_mfma_f32_32x32x16_bf16 v[176:191], a[148:151], a[24:27], v[176:191]
    s_waitcnt vmcnt(14)
    s_barrier
    ds_read_b64_tr_b16 a[128:129], v38 offset:0
    ds_read_b64_tr_b16 a[130:131], v38 offset:512
    v_add_f32 v243, v243, v213
    v_add_f32 v240, v240, v198
    v_add_f32 v241, v241, v222
    v_add_f32 v242, v242, v206
    v_add_f32 v243, v243, v214
    v_add_f32 v240, v240, v199
    v_add_f32 v241, v241, v223
    v_add_f32 v242, v242, v207
    v_add_f32 v243, v243, v215
    v_permlane32_swap_b32 v240, v241
    s_nop 0
    v_permlane32_swap_b32 v242, v243
    v_add_f32 v240, v240, v241
    v_add_f32 v242, v242, v243
    v_rcp_f32 v240, v240
    v_rcp_f32 v242, v242
    v_mov_b32 v241, v240
    v_mov_b32 v243, v242
    v_mfma_f32_32x32x16_bf16 v[160:175], a[144:147], a[24:27], v[160:175]
    ds_read_b64_tr_b16 a[132:133], v39 offset:0
    ds_read_b64_tr_b16 a[134:135], v39 offset:512
    buffer_load_dwordx4 v16, s[12:15], s101 offen offset:2048 lds
    v_permlane32_swap_b32 v240, v241
    v_permlane32_swap_b32 v242, v243
    v_mul_f32 v192, v240, v192
    v_mul_f32 v193, v240, v193
    v_mul_f32 v194, v240, v194
    v_mul_f32 v195, v240, v195
    v_mul_f32 v196, v240, v196
    v_mul_f32 v197, v240, v197
    v_mul_f32 v198, v240, v198
    v_mul_f32 v199, v240, v199
    v_cvt_pk_bf16_f32 v224, v192, v193
    v_cvt_pk_bf16_f32 v225, v194, v195
    v_cvt_pk_bf16_f32 v226, v196, v197
    v_cvt_pk_bf16_f32 v227, v198, v199
    s_waitcnt lgkmcnt(4)
    v_mfma_f32_32x32x16_bf16 v[176:191], a[156:159], a[28:31], v[176:191]
    ds_read_b64_tr_b16 a[136:137], v38 offset:2048
    ds_read_b64_tr_b16 a[138:139], v38 offset:2560
    ds_write_b128 v8, v[224:227] offset:16384
    v_mul_f32 v200, v242, v200
    v_mul_f32 v201, v242, v201
    v_mul_f32 v202, v242, v202
    v_mul_f32 v203, v242, v203
    v_mul_f32 v204, v242, v204
    v_mul_f32 v205, v242, v205
    v_mul_f32 v206, v242, v206
    v_mul_f32 v207, v242, v207
    v_cvt_pk_bf16_f32 v228, v200, v201
    v_cvt_pk_bf16_f32 v229, v202, v203
    v_cvt_pk_bf16_f32 v230, v204, v205
    v_cvt_pk_bf16_f32 v231, v206, v207
    v_mfma_f32_32x32x16_bf16 v[160:175], a[152:155], a[28:31], v[160:175]
    ds_read_b64_tr_b16 a[140:141], v39 offset:2048
    ds_read_b64_tr_b16 a[142:143], v39 offset:2560
    buffer_load_dwordx4 v17, s[12:15], s101 offen offset:3072 lds
    ds_write_b128 v8, v[228:231] offset:20480
    v_mul_f32 v216, v241, v216
    v_mul_f32 v217, v241, v217
    v_mul_f32 v218, v241, v218
    v_mul_f32 v219, v241, v219
    v_mul_f32 v220, v241, v220
    v_mul_f32 v221, v241, v221
    v_mul_f32 v222, v241, v222
    v_mul_f32 v223, v241, v223
    v_cvt_pk_bf16_f32 v232, v216, v217
    v_cvt_pk_bf16_f32 v233, v218, v219
    v_cvt_pk_bf16_f32 v234, v220, v221
    v_cvt_pk_bf16_f32 v235, v222, v223
    s_waitcnt lgkmcnt(6)
    v_mfma_f32_32x32x16_bf16 v[176:191], a[132:135], a[32:35], v[176:191]
    ds_read_b64_tr_b16 a[144:145], v38 offset:4096
    ds_read_b64_tr_b16 a[146:147], v38 offset:4608
    ds_write_b128 v8, v[232:235] offset:24576
    v_mul_f32 v208, v243, v208
    v_mul_f32 v209, v243, v209
    v_mul_f32 v210, v243, v210
    v_mul_f32 v211, v243, v211
    v_mul_f32 v212, v243, v212
    v_mul_f32 v213, v243, v213
    v_mul_f32 v214, v243, v214
    v_mul_f32 v215, v243, v215
    v_cvt_pk_bf16_f32 v236, v208, v209
    v_cvt_pk_bf16_f32 v237, v210, v211
    v_cvt_pk_bf16_f32 v238, v212, v213
    v_cvt_pk_bf16_f32 v239, v214, v215
    v_mfma_f32_32x32x16_bf16 v[160:175], a[128:131], a[32:35], v[160:175]
    ds_read_b64_tr_b16 a[148:149], v39 offset:4096
    ds_read_b64_tr_b16 a[150:151], v39 offset:4608
    ds_write_b128 v8, v[236:239] offset:28672
    v_max3_f32 v240, v64, v65, v66
    v_max3_f32 v241, v88, v89, v90
    v_min3_f32 v242, v64, v65, v66
    v_min3_f32 v243, v88, v89, v90
    v_max3_f32 v240, v240, v67, v68
    v_max3_f32 v241, v241, v91, v92
    v_min3_f32 v242, v242, v67, v68
    v_min3_f32 v243, v243, v91, v92
    v_max3_f32 v240, v240, v69, v70
    v_max3_f32 v241, v241, v93, v94
    v_min3_f32 v242, v242, v69, v70
    v_min3_f32 v243, v243, v93, v94
    v_max_f32 v240, v240, v71
    v_max_f32 v241, v241, v95
    v_min_f32 v242, v242, v71
    v_min_f32 v243, v243, v95
    v_permlane32_swap_b32 v240, v241
    s_nop 0
    v_permlane32_swap_b32 v242, v243
    v_max_f32 v240, v240, v241
    v_min_f32 v242, v242, v243
    v_mul_f32 v241, s51, v240
    v_mul_f32 v240, s51, v240
    v_mul_f32 v243, s51, v242
    v_mul_f32 v242, s51, v242
    v_permlane32_swap_b32 v240, v241
    s_nop 0
    v_permlane32_swap_b32 v242, v243
    s_waitcnt lgkmcnt(7)
    v_mfma_f32_32x32x16_bf16 v[176:191], a[140:143], a[36:39], v[176:191]
    ds_read_b64_tr_b16 a[152:153], v38 offset:6144
    ds_read_b64_tr_b16 a[154:155], v38 offset:6656
    v_fma_f32 v72, v64, -s51, v242
    v_fma_f32 v73, v65, -s51, v242
    v_fma_f32 v74, v66, -s51, v242
    v_fma_f32 v75, v67, -s51, v242
    v_fma_f32 v64, v64, s51, -v240
    v_fma_f32 v65, v65, s51, -v240
    v_fma_f32 v66, v66, s51, -v240
    v_fma_f32 v67, v67, s51, -v240
    v_exp_f32 v72, v72
    v_exp_f32 v73, v73
    v_exp_f32 v74, v74
    v_exp_f32 v75, v75
    v_exp_f32 v64, v64
    v_exp_f32 v65, v65
    v_exp_f32 v66, v66
    v_mfma_f32_32x32x16_bf16 v[160:175], a[136:139], a[36:39], v[160:175]
    ds_read_b64_tr_b16 a[156:157], v39 offset:6144
    ds_read_b64_tr_b16 a[158:159], v39 offset:6656
    v_exp_f32 v67, v67
    v_fma_f32 v76, v68, -s51, v242
    v_fma_f32 v77, v69, -s51, v242
    v_fma_f32 v78, v70, -s51, v242
    v_fma_f32 v79, v71, -s51, v242
    v_fma_f32 v68, v68, s51, -v240
    v_fma_f32 v69, v69, s51, -v240
    v_fma_f32 v70, v70, s51, -v240
    v_fma_f32 v71, v71, s51, -v240
    v_exp_f32 v76, v76
    v_exp_f32 v77, v77
    v_exp_f32 v78, v78
    v_exp_f32 v79, v79
    v_exp_f32 v68, v68
    s_waitcnt lgkmcnt(5)
    v_mfma_f32_32x32x16_bf16 v[176:191], a[148:151], a[40:43], v[176:191]
    ds_read_b64_tr_b16 a[128:129], v38 offset:8192
    ds_read_b64_tr_b16 a[130:131], v38 offset:8704
    v_exp_f32 v69, v69
    v_exp_f32 v70, v70
    v_exp_f32 v71, v71
    v_fma_f32 v80, v88, -s51, v243
    v_fma_f32 v81, v89, -s51, v243
    v_fma_f32 v82, v90, -s51, v243
    v_fma_f32 v83, v91, -s51, v243
    v_fma_f32 v88, v88, s51, -v241
    v_fma_f32 v89, v89, s51, -v241
    v_fma_f32 v90, v90, s51, -v241
    v_fma_f32 v91, v91, s51, -v241
    v_exp_f32 v80, v80
    v_exp_f32 v81, v81
    v_exp_f32 v82, v82
    v_exp_f32 v83, v83
    v_mfma_f32_32x32x16_bf16 v[160:175], a[144:147], a[40:43], v[160:175]
    ds_read_b64_tr_b16 a[132:133], v39 offset:8192
    ds_read_b64_tr_b16 a[134:135], v39 offset:8704
    v_exp_f32 v88, v88
    v_exp_f32 v89, v89
    v_exp_f32 v90, v90
    v_exp_f32 v91, v91
    v_fma_f32 v84, v92, -s51, v243
    v_fma_f32 v85, v93, -s51, v243
    v_fma_f32 v86, v94, -s51, v243
    v_fma_f32 v87, v95, -s51, v243
    v_fma_f32 v92, v92, s51, -v241
    v_fma_f32 v93, v93, s51, -v241
    v_fma_f32 v94, v94, s51, -v241
    v_fma_f32 v95, v95, s51, -v241
    v_exp_f32 v84, v84
    v_exp_f32 v85, v85
    s_waitcnt lgkmcnt(4)
    v_mfma_f32_32x32x16_bf16 v[176:191], a[156:159], a[44:47], v[176:191]
    ds_read_b64_tr_b16 a[136:137], v38 offset:10240
    ds_read_b64_tr_b16 a[138:139], v38 offset:10752
    v_exp_f32 v86, v86
    v_exp_f32 v87, v87
    v_exp_f32 v92, v92
    v_exp_f32 v93, v93
    v_exp_f32 v94, v94
    v_exp_f32 v95, v95
    v_add_f32 v240, v64, v65
    v_add_f32 v241, v88, v89
    v_add_f32 v242, v72, v73
    v_add_f32 v243, v80, v81
    v_add_f32 v240, v240, v66
    v_add_f32 v241, v241, v90
    v_add_f32 v242, v242, v74
    v_add_f32 v243, v243, v82
    v_add_f32 v240, v240, v67
    v_add_f32 v241, v241, v91
    v_mfma_f32_32x32x16_bf16 v[160:175], a[152:155], a[44:47], v[160:175]
    ds_read_b64_tr_b16 a[140:141], v39 offset:10240
    ds_read_b64_tr_b16 a[142:143], v39 offset:10752
    v_add_f32 v242, v242, v75
    v_add_f32 v243, v243, v83
    v_add_f32 v240, v240, v68
    v_add_f32 v241, v241, v92
    v_add_f32 v242, v242, v76
    v_add_f32 v243, v243, v84
    v_add_f32 v240, v240, v69
    v_add_f32 v241, v241, v93
    v_add_f32 v242, v242, v77
    v_add_f32 v243, v243, v85
    v_add_f32 v240, v240, v70
    v_add_f32 v241, v241, v94
    v_add_f32 v242, v242, v78
    v_add_f32 v243, v243, v86
    v_add_f32 v240, v240, v71
    v_add_f32 v241, v241, v95
    v_add_f32 v242, v242, v79
    v_add_f32 v243, v243, v87
    v_permlane32_swap_b32 v240, v241
    s_nop 0
    v_permlane32_swap_b32 v242, v243
    s_waitcnt lgkmcnt(4)
    v_mfma_f32_32x32x16_bf16 v[176:191], a[132:135], a[48:51], v[176:191]
    ds_read_b64_tr_b16 a[144:145], v38 offset:12288
    ds_read_b64_tr_b16 a[146:147], v38 offset:12800
    v_add_f32 v240, v240, v241
    v_add_f32 v242, v242, v243
    v_rcp_f32 v240, v240
    v_rcp_f32 v242, v242
    v_mov_b32 v241, v240
    v_mov_b32 v243, v242
    s_nop 0
    v_permlane32_swap_b32 v240, v241
    v_permlane32_swap_b32 v242, v243
    v_mul_f32 v64, v240, v64
    v_mul_f32 v65, v240, v65
    v_mul_f32 v66, v240, v66
    v_mul_f32 v67, v240, v67
    v_mul_f32 v68, v240, v68
    v_mul_f32 v69, v240, v69
    v_mul_f32 v70, v240, v70
    v_mul_f32 v71, v240, v71
    v_mfma_f32_32x32x16_bf16 v[160:175], a[128:131], a[48:51], v[160:175]
    ds_read_b64_tr_b16 a[148:149], v39 offset:12288
    ds_read_b64_tr_b16 a[150:151], v39 offset:12800
    v_cvt_pk_bf16_f32 v224, v64, v65
    v_cvt_pk_bf16_f32 v225, v66, v67
    v_cvt_pk_bf16_f32 v226, v68, v69
    v_cvt_pk_bf16_f32 v227, v70, v71
    s_waitcnt lgkmcnt(4)
    v_mfma_f32_32x32x16_bf16 v[176:191], a[140:143], a[52:55], v[176:191]
    ds_read_b64_tr_b16 a[152:153], v38 offset:14336
    ds_read_b64_tr_b16 a[154:155], v38 offset:14848
    ds_write_b128 v8, v[224:227] offset:32768
    v_mul_f32 v72, v242, v72
    v_mul_f32 v73, v242, v73
    v_mul_f32 v74, v242, v74
    v_mul_f32 v75, v242, v75
    v_mul_f32 v76, v242, v76
    v_mul_f32 v77, v242, v77
    v_mul_f32 v78, v242, v78
    v_mul_f32 v79, v242, v79
    v_cvt_pk_bf16_f32 v228, v72, v73
    v_cvt_pk_bf16_f32 v229, v74, v75
    v_cvt_pk_bf16_f32 v230, v76, v77
    v_cvt_pk_bf16_f32 v231, v78, v79
    v_mfma_f32_32x32x16_bf16 v[160:175], a[136:139], a[52:55], v[160:175]
    ds_read_b64_tr_b16 a[156:157], v39 offset:14336
    ds_read_b64_tr_b16 a[158:159], v39 offset:14848
    ds_write_b128 v8, v[228:231] offset:36864
    v_mul_f32 v88, v241, v88
    v_mul_f32 v89, v241, v89
    v_mul_f32 v90, v241, v90
    v_mul_f32 v91, v241, v91
    v_mul_f32 v92, v241, v92
    v_mul_f32 v93, v241, v93
    v_mul_f32 v94, v241, v94
    v_mul_f32 v95, v241, v95
    v_cvt_pk_bf16_f32 v232, v88, v89
    v_cvt_pk_bf16_f32 v233, v90, v91
    v_cvt_pk_bf16_f32 v234, v92, v93
    v_cvt_pk_bf16_f32 v235, v94, v95
    ds_write_b128 v8, v[232:235] offset:40960
    v_mul_f32 v80, v243, v80
    v_mul_f32 v81, v243, v81
    v_mul_f32 v82, v243, v82
    v_mul_f32 v83, v243, v83
    v_mul_f32 v84, v243, v84
    v_mul_f32 v85, v243, v85
    v_mul_f32 v86, v243, v86
    v_mul_f32 v87, v243, v87
    v_cvt_pk_bf16_f32 v236, v80, v81
    v_cvt_pk_bf16_f32 v237, v82, v83
    v_cvt_pk_bf16_f32 v238, v84, v85
    v_cvt_pk_bf16_f32 v239, v86, v87
    ds_write_b128 v8, v[236:239] offset:45056
    s_waitcnt lgkmcnt(8)
    v_mfma_f32_32x32x16_bf16 v[176:191], a[148:151], a[56:59], v[176:191]
    s_waitcnt vmcnt(12)
    s_waitcnt lgkmcnt(0)
    s_barrier
    ds_read_b64_tr_b16 a[128:129], v38 offset:49152
    ds_read_b64_tr_b16 a[130:131], v38 offset:49664
    ds_read_b64_tr_b16 v[192:193], v58 offset:0
    ds_read_b64_tr_b16 v[194:195], v58 offset:512
    ds_read_b64_tr_b16 v[208:209], v11 offset:0
    ds_read_b64_tr_b16 v[210:211], v11 offset:512
    ds_read_b64_tr_b16 v[224:225], v11 offset:4096
    ds_read_b64_tr_b16 v[226:227], v11 offset:4608
    s_add_u32 m0, s59, 147456
    v_mfma_f32_32x32x16_bf16 v[160:175], a[144:147], a[56:59], v[160:175]
    ds_read_b64_tr_b16 a[132:133], v39 offset:49152
    ds_read_b64_tr_b16 a[134:135], v39 offset:49664
    buffer_load_dwordx4 v18, s[16:19], s92 offen lds
    ds_read_b64_tr_b16 v[196:197], v58 offset:1024
    ds_read_b64_tr_b16 v[198:199], v58 offset:1536
    ds_read_b64_tr_b16 v[212:213], v11 offset:1024
    ds_read_b64_tr_b16 v[214:215], v11 offset:1536
    ds_read_b64_tr_b16 v[228:229], v11 offset:5120
    ds_read_b64_tr_b16 v[230:231], v11 offset:5632
    ds_read_b64_tr_b16 v[200:201], v58 offset:2048
    v_mfma_f32_32x32x16_bf16 v[176:191], a[156:159], a[60:63], v[176:191]
    ds_read_b64_tr_b16 a[136:137], v38 offset:51200
    ds_read_b64_tr_b16 a[138:139], v38 offset:51712
    ds_read_b64_tr_b16 v[202:203], v58 offset:2560
    ds_read_b64_tr_b16 v[216:217], v11 offset:2048
    ds_read_b64_tr_b16 v[218:219], v11 offset:2560
    ds_read_b64_tr_b16 v[232:233], v11 offset:6144
    ds_read_b64_tr_b16 v[234:235], v11 offset:6656
    v_mfma_f32_32x32x16_bf16 v[160:175], a[152:155], a[60:63], v[160:175]
    ds_read_b64_tr_b16 a[140:141], v39 offset:51200
    ds_read_b64_tr_b16 a[142:143], v39 offset:51712
    buffer_load_dwordx4 v19, s[16:19], s92 offen offset:1024 lds
    s_waitcnt lgkmcnt(15)
    v_mfma_f32_16x16x32_bf16 v[244:247], v[192:195], v[224:227], 0
    v_mfma_f32_16x16x32_bf16 v[252:255], a[160:163], v[224:227], 0
    v_mfma_f32_32x32x16_bf16 v[176:191], a[132:135], a[64:67], v[176:191]
    ds_read_b64_tr_b16 a[144:145], v38 offset:53248
    ds_read_b64_tr_b16 a[146:147], v38 offset:53760
    v_mfma_f32_16x16x32_bf16 v[240:243], v[192:195], v[208:211], 0
    s_add_u32 m0, s59, 149504
    v_mfma_f32_32x32x16_bf16 v[160:175], a[128:131], a[64:67], v[160:175]
    ds_read_b64_tr_b16 a[148:149], v39 offset:53248
    ds_read_b64_tr_b16 a[150:151], v39 offset:53760
    buffer_load_dwordx4 v18, s[16:19], s93 offen lds
    v_mfma_f32_16x16x32_bf16 v[248:251], a[160:163], v[208:211], 0
    s_waitcnt lgkmcnt(4)
    v_mfma_f32_32x32x16_bf16 v[176:191], a[140:143], a[68:71], v[176:191]
    ds_read_b64_tr_b16 a[152:153], v38 offset:55296
    ds_read_b64_tr_b16 a[154:155], v38 offset:55808
    ds_read_b64_tr_b16 v[204:205], v58 offset:3072
    ds_read_b64_tr_b16 v[206:207], v58 offset:3584
    ds_read_b64_tr_b16 v[220:221], v11 offset:3072
    ds_read_b64_tr_b16 v[222:223], v11 offset:3584
    ds_read_b64_tr_b16 v[236:237], v11 offset:7168
    ds_read_b64_tr_b16 v[238:239], v11 offset:7680
    v_mfma_f32_16x16x32_bf16 v[244:247], v[196:199], v[228:231], v[244:247]
    v_mfma_f32_32x32x16_bf16 v[160:175], a[136:139], a[68:71], v[160:175]
    ds_read_b64_tr_b16 a[156:157], v39 offset:55296
    ds_read_b64_tr_b16 a[158:159], v39 offset:55808
    buffer_load_dwordx4 v19, s[16:19], s93 offen offset:1024 lds
    v_mfma_f32_16x16x32_bf16 v[252:255], a[160:163], v[228:231], v[252:255]
    v_mfma_f32_16x16x32_bf16 v[240:243], v[196:199], v[212:215], v[240:243]
    s_waitcnt lgkmcnt(10)
    v_mfma_f32_32x32x16_bf16 v[176:191], a[148:151], a[72:75], v[176:191]
    ds_read_b64_tr_b16 a[128:129], v38 offset:57344
    ds_read_b64_tr_b16 a[130:131], v38 offset:57856
    v_mfma_f32_16x16x32_bf16 v[248:251], a[160:163], v[212:215], v[248:251]
    s_add_u32 m0, s59, 114688
    v_mfma_f32_32x32x16_bf16 v[160:175], a[144:147], a[72:75], v[160:175]
    ds_read_b64_tr_b16 a[132:133], v39 offset:57344
    ds_read_b64_tr_b16 a[134:135], v39 offset:57856
    buffer_load_dwordx4 v20, s[16:19], s92 offen lds
    v_mfma_f32_16x16x32_bf16 v[244:247], v[200:203], v[232:235], v[244:247]
    v_mfma_f32_16x16x32_bf16 v[252:255], a[160:163], v[232:235], v[252:255]
    s_waitcnt lgkmcnt(4)
    v_mfma_f32_32x32x16_bf16 v[176:191], a[156:159], a[76:79], v[176:191]
    ds_read_b64_tr_b16 a[136:137], v38 offset:59392
    ds_read_b64_tr_b16 a[138:139], v38 offset:59904
    v_mfma_f32_16x16x32_bf16 v[240:243], v[200:203], v[216:219], v[240:243]
    v_mfma_f32_32x32x16_bf16 v[160:175], a[152:155], a[76:79], v[160:175]
    ds_read_b64_tr_b16 a[140:141], v39 offset:59392
    ds_read_b64_tr_b16 a[142:143], v39 offset:59904
    buffer_load_dwordx4 v21, s[16:19], s92 offen offset:1024 lds
    v_mfma_f32_16x16x32_bf16 v[248:251], a[160:163], v[216:219], v[248:251]
    v_mfma_f32_16x16x32_bf16 v[244:247], v[204:207], v[236:239], v[244:247]
    s_waitcnt lgkmcnt(4)
    v_mfma_f32_32x32x16_bf16 v[176:191], a[132:135], a[80:83], v[176:191]
    ds_read_b64_tr_b16 a[144:145], v38 offset:61440
    ds_read_b64_tr_b16 a[146:147], v38 offset:61952
    v_mfma_f32_16x16x32_bf16 v[252:255], a[160:163], v[236:239], v[252:255]
    s_add_u32 m0, s59, 116736
    v_mfma_f32_32x32x16_bf16 v[160:175], a[128:131], a[80:83], v[160:175]
    ds_read_b64_tr_b16 a[148:149], v39 offset:61440
    ds_read_b64_tr_b16 a[150:151], v39 offset:61952
    buffer_load_dwordx4 v20, s[16:19], s93 offen lds
    v_mfma_f32_16x16x32_bf16 v[240:243], v[204:207], v[220:223], v[240:243]
    v_mfma_f32_16x16x32_bf16 v[248:251], a[160:163], v[220:223], v[248:251]
    s_waitcnt lgkmcnt(4)
    v_mfma_f32_32x32x16_bf16 v[176:191], a[140:143], a[84:87], v[176:191]
    ds_read_b64_tr_b16 a[152:153], v38 offset:63488
    ds_read_b64_tr_b16 a[154:155], v38 offset:64000
    v_mfma_f32_32x32x16_bf16 v[160:175], a[136:139], a[84:87], v[160:175]
    ds_read_b64_tr_b16 a[156:157], v39 offset:63488
    ds_read_b64_tr_b16 a[158:159], v39 offset:64000
    buffer_load_dwordx4 v21, s[16:19], s93 offen offset:1024 lds
    s_waitcnt lgkmcnt(4)
    v_mfma_f32_32x32x16_bf16 v[176:191], a[148:151], a[88:91], v[176:191]
    s_waitcnt vmcnt(16)
    s_barrier
    ds_read_b64_tr_b16 a[128:129], v40 offset:0
    ds_read_b64_tr_b16 a[130:131], v40 offset:512
    v_cvt_pk_bf16_f32 v192, v240, v241
    v_cvt_pk_bf16_f32 v193, v242, v243
    v_cvt_pk_bf16_f32 v194, v244, v245
    v_cvt_pk_bf16_f32 v195, v246, v247
    v_permlane16_swap_b32 v248, v252
    s_add_u32 m0, s59, 0
    v_mfma_f32_32x32x16_bf16 v[160:175], a[144:147], a[88:91], v[160:175]
    ds_read_b64_tr_b16 a[132:133], v41 offset:0
    ds_read_b64_tr_b16 a[134:135], v41 offset:512
    buffer_load_dwordx4 v22, s[16:19], s92 offen lds
    v_permlane16_swap_b32 v192, v194
    v_permlane16_swap_b32 v193, v195
    s_waitcnt lgkmcnt(4)
    v_mfma_f32_32x32x16_bf16 v[176:191], a[156:159], a[92:95], v[176:191]
    ds_read_b64_tr_b16 a[136:137], v40 offset:2048
    ds_read_b64_tr_b16 a[138:139], v40 offset:2560
    buffer_store_dword v248, v3, s[24:27], 0 offen sc1
    buffer_store_dwordx4 v[192:195], v6, s[24:27], 0 offen sc1
    v_readfirstlane_b32 s55, v62
    s_nop 0
    s_cmp_eq_u32 s55, 0
    s_cbranch_scc1 L_retry_A_tag
L_back_A_tag:
    buffer_load_dword v54, v53, s[24:27], 0 offen sc1
    v_mfma_f32_32x32x16_bf16 v[160:175], a[152:155], a[92:95], v[160:175]
    ds_read_b64_tr_b16 a[140:141], v41 offset:2048
    ds_read_b64_tr_b16 a[142:143], v41 offset:2560
    buffer_load_dwordx4 v23, s[16:19], s92 offen offset:1024 lds
    s_waitcnt lgkmcnt(4)
    v_mfma_f32_32x32x16_bf16 v[176:191], a[132:135], a[96:99], v[176:191]
    ds_read_b64_tr_b16 a[144:145], v40 offset:4096
    ds_read_b64_tr_b16 a[146:147], v40 offset:4608
    s_waitcnt vmcnt(9)
    ds_read_b64_tr_b16 v[128:129], v48 offset:16384
    ds_read_b64_tr_b16 v[130:131], v48 offset:17408
    ds_read_b64_tr_b16 v[132:133], v49 offset:16384
    ds_read_b64_tr_b16 v[134:135], v49 offset:17408
    s_add_u32 m0, s59, 2048
    v_mfma_f32_32x32x16_bf16 v[160:175], a[128:131], a[96:99], v[160:175]
    ds_read_b64_tr_b16 a[148:149], v41 offset:4096
    ds_read_b64_tr_b16 a[150:151], v41 offset:4608
    ds_read_b64_tr_b16 v[136:137], v48 offset:18432
    ds_read_b64_tr_b16 v[138:139], v48 offset:19456
    ds_read_b64_tr_b16 v[140:141], v49 offset:18432
    ds_read_b64_tr_b16 v[142:143], v49 offset:19456
    buffer_load_dwordx4 v22, s[16:19], s93 offen lds
    s_waitcnt lgkmcnt(12)
    v_mfma_f32_32x32x16_bf16 v[176:191], a[140:143], a[100:103], v[176:191]
    ds_read_b64_tr_b16 a[152:153], v40 offset:6144
    ds_read_b64_tr_b16 a[154:155], v40 offset:6656
    v_mfma_f32_32x32x16_bf16 v[160:175], a[136:139], a[100:103], v[160:175]
    ds_read_b64_tr_b16 a[156:157], v41 offset:6144
    ds_read_b64_tr_b16 a[158:159], v41 offset:6656
    buffer_load_dwordx4 v23, s[16:19], s93 offen offset:1024 lds
    s_waitcnt lgkmcnt(8)
    v_mfma_f32_32x32x16_bf16 v[176:191], a[148:151], a[104:107], v[176:191]
    ds_read_b64_tr_b16 a[128:129], v40 offset:8192
    ds_read_b64_tr_b16 a[130:131], v40 offset:8704
    s_add_u32 m0, s59, 147456
    v_mfma_f32_32x32x16_bf16 v[160:175], a[144:147], a[104:107], v[160:175]
    ds_read_b64_tr_b16 a[132:133], v41 offset:8192
    ds_read_b64_tr_b16 a[134:135], v41 offset:8704
    s_waitcnt lgkmcnt(8)
    buffer_load_dwordx4 v18, s[16:19], s94 offen lds
    s_waitcnt lgkmcnt(4)
    v_mfma_f32_32x32x16_bf16 v[176:191], a[156:159], a[108:111], v[176:191]
    ds_read_b64_tr_b16 a[136:137], v40 offset:10240
    ds_read_b64_tr_b16 a[138:139], v40 offset:10752
    v_mfma_f32_32x32x16_bf16 v[160:175], a[152:155], a[108:111], v[160:175]
    ds_read_b64_tr_b16 a[140:141], v41 offset:10240
    ds_read_b64_tr_b16 a[142:143], v41 offset:10752
    buffer_load_dwordx4 v19, s[16:19], s94 offen offset:1024 lds
    s_waitcnt lgkmcnt(4)
    v_mfma_f32_32x32x16_bf16 v[176:191], a[132:135], a[112:115], v[176:191]
    ds_read_b64_tr_b16 a[144:145], v40 offset:12288
    ds_read_b64_tr_b16 a[146:147], v40 offset:12800
    s_load_dword s39, s[24:25], s38 offset:0 glc
    s_add_u32 m0, s59, 149504
    v_mfma_f32_32x32x16_bf16 v[160:175], a[128:131], a[112:115], v[160:175]
    ds_read_b64_tr_b16 a[148:149], v41 offset:12288
    ds_read_b64_tr_b16 a[150:151], v41 offset:12800
    buffer_load_dwordx4 v18, s[16:19], s95 offen lds
    s_waitcnt lgkmcnt(4)
    v_mfma_f32_32x32x16_bf16 v[176:191], a[140:143], a[116:119], v[176:191]
    ds_read_b64_tr_b16 a[152:153], v40 offset:14336
    ds_read_b64_tr_b16 a[154:155], v40 offset:14848
    v_mfma_f32_32x32x16_bf16 v[160:175], a[136:139], a[116:119], v[160:175]
    ds_read_b64_tr_b16 a[156:157], v41 offset:14336
    ds_read_b64_tr_b16 a[158:159], v41 offset:14848
    buffer_load_dwordx4 v19, s[16:19], s95 offen offset:1024 lds
    s_waitcnt lgkmcnt(4)
    v_mfma_f32_32x32x16_bf16 v[176:191], a[148:151], a[120:123], v[176:191]
    s_barrier
    ds_read_b64_tr_b16 a[128:129], v51 offset:16384
    ds_read_b64_tr_b16 a[130:131], v51 offset:16640
    s_add_u32 m0, s59, 16384
    s_lshl_b32 s54, s84, 4
    v_mfma_f32_32x32x16_bf16 v[176:191], a[178:181], a[186:189], v[176:191]
    buffer_load_dwordx4 v26, s[20:23], s54 offen lds
    v_mfma_f32_32x32x16_bf16 v[160:175], a[144:147], a[120:123], v[160:175]
    v_mov_b32 v61, 1
    v_mfma_f32_32x32x16_bf16 v[160:175], a[176:179], a[186:189], v[160:175]
    buffer_load_dwordx4 v27, s[20:23], s54 offen offset:1024 lds
    s_waitcnt vmcnt(10)
    s_mov_b64 exec, 1
    buffer_atomic_add v61, off, s[24:27], s37 offset:0 sc1
    s_mov_b64 exec, -1
    s_waitcnt lgkmcnt(2)
    v_mfma_f32_32x32x16_bf16 v[176:191], a[156:159], a[124:127], v[176:191]
    ds_read_b64_tr_b16 a[136:137], v51 offset:17408
    ds_read_b64_tr_b16 a[138:139], v51 offset:17664
    s_add_u32 m0, s59, 18432
    s_lshl_b32 s54, s85, 4
    v_mfma_f32_32x32x16_bf16 v[160:175], a[152:155], a[124:127], v[160:175]
    buffer_load_dwordx4 v26, s[20:23], s54 offen lds
    s_waitcnt lgkmcnt(2)
    v_mfma_f32_32x32x16_bf16 v[64:79], a[128:131], a[0:3], 0
    ds_read_b64_tr_b16 a[144:145], v51 offset:18432
    ds_read_b64_tr_b16 a[146:147], v51 offset:18688
    s_waitcnt lgkmcnt(2)
    v_mfma_f32_32x32x16_bf16 v[64:79], a[136:139], a[4:7], v[64:79]
    ds_read_b64_tr_b16 a[152:153], v51 offset:19456
    ds_read_b64_tr_b16 a[154:155], v51 offset:19712
    buffer_load_dwordx4 v27, s[20:23], s54 offen offset:1024 lds
    s_waitcnt lgkmcnt(2)
    v_mfma_f32_32x32x16_bf16 v[64:79], a[144:147], a[8:11], v[64:79]
    ds_read_b64_tr_b16 a[128:129], v51 offset:20480
    ds_read_b64_tr_b16 a[130:131], v51 offset:20736
    s_add_u32 m0, s59, 32768
    s_and_b32 s54, s92, 0xc000
    s_waitcnt lgkmcnt(2)
    v_mfma_f32_32x32x16_bf16 v[64:79], a[152:155], a[12:15], v[64:79]
    ds_read_b64_tr_b16 a[136:137], v51 offset:21504
    ds_read_b64_tr_b16 a[138:139], v51 offset:21760
    buffer_load_dwordx4 v24, s[16:19], s54 offen lds
    s_waitcnt vmcnt(13)
    v_cmp_gt_i32 vcc, 0, v54
    s_nop 0
    s_andn2_b64 s[48:49], exec, vcc
    s_cbranch_scc1 L_retry_A_gate
L_back_A_gate:
    v_add_f32 v55, 1.0, v54
    v_mul_f32 v56, -2.0, v55
    v_mul_f32 v232, s51, v160
    v_mul_f32 v233, s51, v161
    v_mul_f32 v234, s51, v162
    v_mul_f32 v235, s51, v163
    v_exp_f32 v232, v232
    s_waitcnt lgkmcnt(2)
    v_mfma_f32_32x32x16_bf16 v[64:79], a[128:131], a[16:19], v[64:79]
    ds_read_b64_tr_b16 a[144:145], v51 offset:22528
    ds_read_b64_tr_b16 a[146:147], v51 offset:22784
    s_waitcnt vmcnt(6)
    ds_read_b64_tr_b16 v[144:145], v48 offset:16384
    ds_read_b64_tr_b16 v[146:147], v48 offset:17408
    ds_read_b64_tr_b16 v[148:149], v49 offset:16384
    ds_read_b64_tr_b16 v[150:151], v49 offset:17408
    v_exp_f32 v233, v233
    v_exp_f32 v234, v234
    v_exp_f32 v235, v235
    v_add_f32 v232, 1.0, v232
    v_add_f32 v233, 1.0, v233
    v_add_f32 v234, 1.0, v234
    v_add_f32 v235, 1.0, v235
    v_fma_f32 v232, v232, v232, 1.0
    v_fma_f32 v233, v233, v233, 1.0
    s_waitcnt lgkmcnt(6)
    v_mfma_f32_32x32x16_bf16 v[64:79], a[136:139], a[20:23], v[64:79]
    s_waitcnt lgkmcnt(0)
    s_cmp_lt_u32 s39, 4
    s_cbranch_scc1 L_retry_A_b0
L_back_A_b0:
    ds_read_b64_tr_b16 a[152:153], v51 offset:23552
    ds_read_b64_tr_b16 a[154:155], v51 offset:23808
    ds_read_b64_tr_b16 v[152:153], v48 offset:18432
    ds_read_b64_tr_b16 v[154:155], v48 offset:19456
    ds_read_b64_tr_b16 v[156:157], v49 offset:18432
    ds_read_b64_tr_b16 v[158:159], v49 offset:19456
    buffer_load_dwordx4 v25, s[16:19], s54 offen offset:1024 lds
    buffer_load_dwordx4 a[192:195], v28, s[24:27], s84 offen sc1
    v_fma_f32 v234, v234, v234, 1.0
    v_fma_f32 v235, v235, v235, 1.0
    v_rcp_f32 v232, v232
    v_rcp_f32 v233, v233
    v_rcp_f32 v234, v234
    v_rcp_f32 v235, v235
    v_fma_f32 v232, v232, v56, v55
    v_mfma_f32_32x32x16_bf16 v[64:79], a[144:147], a[24:27], v[64:79]
    ds_read_b64_tr_b16 a[128:129], v51 offset:24576
    ds_read_b64_tr_b16 a[130:131], v51 offset:24832
    v_fma_f32 v233, v233, v56, v55
    v_fma_f32 v234, v234, v56, v55
    v_fma_f32 v235, v235, v56, v55
    v_mul_f32 v232, v160, v232
    v_mul_f32 v233, v161, v233
    v_mul_f32 v234, v162, v234
    v_mul_f32 v235, v163, v235
    v_cvt_pk_bf16_f32 v240, v232, v233
    v_cvt_pk_bf16_f32 v241, v234, v235
    v_mul_f32 v236, s51, v164
    v_mul_f32 v237, s51, v165
    v_mul_f32 v238, s51, v166
    s_add_u32 m0, s59, 34816
    s_and_b32 s54, s93, 0xc000
    s_waitcnt lgkmcnt(6)
    v_mfma_f32_32x32x16_bf16 v[64:79], a[152:155], a[28:31], v[64:79]
    ds_read_b64_tr_b16 a[136:137], v51 offset:25600
    ds_read_b64_tr_b16 a[138:139], v51 offset:25856
    buffer_load_dwordx4 v24, s[16:19], s54 offen lds
    buffer_load_dwordx4 a[196:199], v29, s[24:27], s84 offen sc1
    v_mul_f32 v239, s51, v167
    v_exp_f32 v236, v236
    v_exp_f32 v237, v237
    v_exp_f32 v238, v238
    v_exp_f32 v239, v239
    v_add_f32 v236, 1.0, v236
    v_add_f32 v237, 1.0, v237
    s_waitcnt lgkmcnt(2)
    v_mfma_f32_32x32x16_bf16 v[64:79], a[128:131], a[32:35], v[64:79]
    ds_read_b64_tr_b16 a[144:145], v51 offset:26624
    ds_read_b64_tr_b16 a[146:147], v51 offset:26880
    buffer_load_dwordx4 a[200:203], v28, s[24:27], s85 offen sc1
    v_add_f32 v238, 1.0, v238
    v_add_f32 v239, 1.0, v239
    v_fma_f32 v236, v236, v236, 1.0
    v_fma_f32 v237, v237, v237, 1.0
    v_fma_f32 v238, v238, v238, 1.0
    v_fma_f32 v239, v239, v239, 1.0
    v_rcp_f32 v236, v236
    v_rcp_f32 v237, v237
    v_rcp_f32 v238, v238
    s_waitcnt lgkmcnt(2)
    v_mfma_f32_32x32x16_bf16 v[64:79], a[136:139], a[36:39], v[64:79]
    ds_read_b64_tr_b16 a[152:153], v51 offset:27648
    ds_read_b64_tr_b16 a[154:155], v51 offset:27904
    buffer_load_dwordx4 v25, s[16:19], s54 offen offset:1024 lds
    v_rcp_f32 v239, v239
    v_fma_f32 v236, v236, v56, v55
    v_fma_f32 v237, v237, v56, v55
    v_fma_f32 v238, v238, v56, v55
    v_fma_f32 v239, v239, v56, v55
    v_mul_f32 v236, v164, v236
    v_mul_f32 v237, v165, v237
    v_mul_f32 v238, v166, v238
    v_mul_f32 v239, v167, v239
    v_cvt_pk_bf16_f32 v242, v236, v237
    s_waitcnt lgkmcnt(2)
    v_mfma_f32_32x32x16_bf16 v[64:79], a[144:147], a[40:43], v[64:79]
    ds_read_b64_tr_b16 a[128:129], v51 offset:28672
    ds_read_b64_tr_b16 a[130:131], v51 offset:28928
    buffer_load_dwordx4 a[204:207], v29, s[24:27], s85 offen sc1
    v_cvt_pk_bf16_f32 v243, v238, v239
    v_mul_f32 v232, s51, v168
    v_mul_f32 v233, s51, v169
    v_mul_f32 v234, s51, v170
    v_mul_f32 v235, s51, v171
    v_exp_f32 v232, v232
    v_exp_f32 v233, v233
    v_exp_f32 v234, v234
    s_add_u32 m0, s59, 131072
    s_waitcnt lgkmcnt(2)
    v_mfma_f32_32x32x16_bf16 v[64:79], a[152:155], a[44:47], v[64:79]
    ds_read_b64_tr_b16 a[136:137], v51 offset:29696
    ds_read_b64_tr_b16 a[138:139], v51 offset:29952
    buffer_load_dwordx4 v18, s[16:19], s96 offen lds
    buffer_load_dwordx4 a[208:211], v28, s[24:27], s86 offen sc1
    v_exp_f32 v235, v235
    v_add_f32 v232, 1.0, v232
    v_add_f32 v233, 1.0, v233
    v_add_f32 v234, 1.0, v234
    v_add_f32 v235, 1.0, v235
    v_fma_f32 v232, v232, v232, 1.0
    v_fma_f32 v233, v233, v233, 1.0
    v_fma_f32 v234, v234, v234, 1.0
    v_fma_f32 v235, v235, v235, 1.0
    v_rcp_f32 v232, v232
    s_waitcnt lgkmcnt(2)
    v_mfma_f32_32x32x16_bf16 v[64:79], a[128:131], a[48:51], v[64:79]
    ds_read_b64_tr_b16 a[144:145], v51 offset:30720
    ds_read_b64_tr_b16 a[146:147], v51 offset:30976
    v_rcp_f32 v233, v233
    v_rcp_f32 v234, v234
    v_rcp_f32 v235, v235
    v_fma_f32 v232, v232, v56, v55
    v_fma_f32 v233, v233, v56, v55
    v_fma_f32 v234, v234, v56, v55
    v_fma_f32 v235, v235, v56, v55
    v_mul_f32 v232, v168, v232
    s_waitcnt lgkmcnt(2)
    v_mfma_f32_32x32x16_bf16 v[64:79], a[136:139], a[52:55], v[64:79]
    ds_read_b64_tr_b16 a[152:153], v51 offset:31744
    ds_read_b64_tr_b16 a[154:155], v51 offset:32000
    buffer_load_dwordx4 v19, s[16:19], s96 offen offset:1024 lds
    buffer_load_dwordx4 a[212:215], v29, s[24:27], s86 offen sc1
    v_mul_f32 v233, v169, v233
    v_mul_f32 v234, v170, v234
    v_mul_f32 v235, v171, v235
    v_cvt_pk_bf16_f32 v244, v232, v233
    v_cvt_pk_bf16_f32 v245, v234, v235
    v_mul_f32 v236, s51, v172
    v_mul_f32 v237, s51, v173
    v_mul_f32 v238, s51, v174
    v_mul_f32 v239, s51, v175
    v_exp_f32 v236, v236
    s_waitcnt lgkmcnt(2)
    v_mfma_f32_32x32x16_bf16 v[64:79], a[144:147], a[56:59], v[64:79]
    s_barrier
    ds_read_b64_tr_b16 a[128:129], v51 offset:32768
    ds_read_b64_tr_b16 a[130:131], v51 offset:33024
    buffer_load_dwordx4 a[216:219], v28, s[24:27], s87 offen sc1
    v_exp_f32 v237, v237
    v_exp_f32 v238, v238
    v_exp_f32 v239, v239
    v_add_f32 v236, 1.0, v236
    v_add_f32 v237, 1.0, v237
    v_add_f32 v238, 1.0, v238
    v_add_f32 v239, 1.0, v239
    v_fma_f32 v236, v236, v236, 1.0
    v_fma_f32 v237, v237, v237, 1.0
    s_add_u32 m0, s59, 133120
    s_waitcnt lgkmcnt(2)
    v_mfma_f32_32x32x16_bf16 v[64:79], a[152:155], a[60:63], v[64:79]
    ds_read_b64_tr_b16 a[136:137], v51 offset:33792
    ds_read_b64_tr_b16 a[138:139], v51 offset:34048
    buffer_load_dwordx4 v18, s[16:19], s97 offen lds
    v_fma_f32 v238, v238, v238, 1.0
    v_fma_f32 v239, v239, v239, 1.0
    v_rcp_f32 v236, v236
    v_rcp_f32 v237, v237
    v_rcp_f32 v238, v238
    v_rcp_f32 v239, v239
    v_fma_f32 v236, v236, v56, v55
    v_fma_f32 v237, v237, v56, v55
    s_waitcnt lgkmcnt(2)
    v_mfma_f32_32x32x16_bf16 v[64:79], a[128:131], a[64:67], v[64:79]
    ds_read_b64_tr_b16 a[144:145], v51 offset:34816
    ds_read_b64_tr_b16 a[146:147], v51 offset:35072
    buffer_load_dwordx4 a[220:223], v29, s[24:27], s87 offen sc1
    v_fma_f32 v238, v238, v56, v55
    v_fma_f32 v239, v239, v56, v55
    v_mul_f32 v236, v172, v236
    v_mul_f32 v237, v173, v237
    v_mul_f32 v238, v174, v238
    v_mul_f32 v239, v175, v239
    v_cvt_pk_bf16_f32 v246, v236, v237
    v_cvt_pk_bf16_f32 v247, v238, v239
    v_mul_f32 v232, s51, v176
    v_mul_f32 v233, s51, v177
    v_mul_f32 v234, s51, v178
    s_waitcnt lgkmcnt(2)
    v_mfma_f32_32x32x16_bf16 v[64:79], a[136:139], a[68:71], v[64:79]
    ds_read_b64_tr_b16 a[152:153], v51 offset:35840
    ds_read_b64_tr_b16 a[154:155], v51 offset:36096
    buffer_load_dwordx4 v19, s[16:19], s97 offen offset:1024 lds
    buffer_load_dwordx4 a[224:227], v28, s[24:27], s88 offen sc1
    v_mul_f32 v235, s51, v179
    v_exp_f32 v232, v232
    v_exp_f32 v233, v233
    v_exp_f32 v234, v234
    v_exp_f32 v235, v235
    v_add_f32 v232, 1.0, v232
    v_add_f32 v233, 1.0, v233
    v_add_f32 v234, 1.0, v234
    s_waitcnt lgkmcnt(2)
    v_mfma_f32_32x32x16_bf16 v[64:79], a[144:147], a[72:75], v[64:79]
    ds_read_b64_tr_b16 a[128:129], v51 offset:36864
    ds_read_b64_tr_b16 a[130:131], v51 offset:37120
    v_add_f32 v235, 1.0, v235
    v_fma_f32 v232, v232, v232, 1.0
    v_fma_f32 v233, v233, v233, 1.0
    v_fma_f32 v234, v234, v234, 1.0
    v_fma_f32 v235, v235, v235, 1.0
    v_rcp_f32 v232, v232
    v_rcp_f32 v233, v233
    v_rcp_f32 v234, v234
    s_add_u32 m0, s59, 49152
    s_waitcnt lgkmcnt(2)
    v_mfma_f32_32x32x16_bf16 v[64:79], a[152:155], a[76:79], v[64:79]
    ds_read_b64_tr_b16 a[136:137], v51 offset:37888
    ds_read_b64_tr_b16 a[138:139], v51 offset:38144
    buffer_load_dwordx4 v18, s[16:19], s98 offen lds
    buffer_load_dwordx4 a[228:231], v29, s[24:27], s88 offen sc1
    v_rcp_f32 v235, v235
    v_fma_f32 v232, v232, v56, v55
    v_fma_f32 v233, v233, v56, v55
    v_fma_f32 v234, v234, v56, v55
    v_fma_f32 v235, v235, v56, v55
    v_mul_f32 v232, v176, v232
    v_mul_f32 v233, v177, v233
    v_mul_f32 v234, v178, v234
    v_mul_f32 v235, v179, v235
    v_cvt_pk_bf16_f32 v248, v232, v233
    v_cvt_pk_bf16_f32 v249, v234, v235
    s_waitcnt lgkmcnt(2)
    v_mfma_f32_32x32x16_bf16 v[64:79], a[128:131], a[80:83], v[64:79]
    ds_read_b64_tr_b16 a[144:145], v51 offset:38912
    ds_read_b64_tr_b16 a[146:147], v51 offset:39168
    buffer_load_dwordx4 a[232:235], v28, s[24:27], s89 offen sc1
    v_mul_f32 v236, s51, v180
    v_mul_f32 v237, s51, v181
    v_mul_f32 v238, s51, v182
    v_mul_f32 v239, s51, v183
    v_exp_f32 v236, v236
    v_exp_f32 v237, v237
    v_exp_f32 v238, v238
    v_exp_f32 v239, v239
    s_waitcnt lgkmcnt(2)
    v_mfma_f32_32x32x16_bf16 v[64:79], a[136:139], a[84:87], v[64:79]
    ds_read_b64_tr_b16 a[152:153], v51 offset:39936
    ds_read_b64_tr_b16 a[154:155], v51 offset:40192
    buffer_load_dwordx4 v19, s[16:19], s98 offen offset:1024 lds
    v_add_f32 v236, 1.0, v236
    v_add_f32 v237, 1.0, v237
    v_add_f32 v238, 1.0, v238
    v_add_f32 v239, 1.0, v239
    v_fma_f32 v236, v236, v236, 1.0
    v_fma_f32 v237, v237, v237, 1.0
    v_fma_f32 v238, v238, v238, 1.0
    v_fma_f32 v239, v239, v239, 1.0
    v_rcp_f32 v236, v236
    s_waitcnt lgkmcnt(2)
    v_mfma_f32_32x32x16_bf16 v[64:79], a[144:147], a[88:91], v[64:79]
    ds_read_b64_tr_b16 a[128:129], v51 offset:40960
    ds_read_b64_tr_b16 a[130:131], v51 offset:41216
    buffer_load_dwordx4 a[236:239], v29, s[24:27], s89 offen sc1
    v_rcp_f32 v237, v237
    v_rcp_f32 v238, v238
    v_rcp_f32 v239, v239
    v_fma_f32 v236, v236, v56, v55
    v_fma_f32 v237, v237, v56, v55
    v_fma_f32 v238, v238, v56, v55
    v_fma_f32 v239, v239, v56, v55
    v_mul_f32 v236, v180, v236
    v_mul_f32 v237, v181, v237
    s_add_u32 m0, s59, 51200
    s_waitcnt lgkmcnt(2)
    v_mfma_f32_32x32x16_bf16 v[64:79], a[152:155], a[92:95], v[64:79]
    ds_read_b64_tr_b16 a[136:137], v51 offset:41984
    ds_read_b64_tr_b16 a[138:139], v51 offset:42240
    buffer_load_dwordx4 v18, s[16:19], s99 offen lds
    buffer_load_dwordx4 a[240:243], v28, s[24:27], s90 offen sc1
    v_mul_f32 v238, v182, v238
    v_mul_f32 v239, v183, v239
    v_cvt_pk_bf16_f32 v250, v236, v237
    v_cvt_pk_bf16_f32 v251, v238, v239
    v_mul_f32 v232, s51, v184
    v_mul_f32 v233, s51, v185
    v_mul_f32 v234, s51, v186
    v_mul_f32 v235, s51, v187
    v_exp_f32 v232, v232
    v_exp_f32 v233, v233
    s_waitcnt lgkmcnt(2)
    v_mfma_f32_32x32x16_bf16 v[64:79], a[128:131], a[96:99], v[64:79]
    ds_read_b64_tr_b16 a[144:145], v51 offset:43008
    ds_read_b64_tr_b16 a[146:147], v51 offset:43264
    v_exp_f32 v234, v234
    v_exp_f32 v235, v235
    v_add_f32 v232, 1.0, v232
    v_add_f32 v233, 1.0, v233
    v_add_f32 v234, 1.0, v234
    v_add_f32 v235, 1.0, v235
    v_fma_f32 v232, v232, v232, 1.0
    v_fma_f32 v233, v233, v233, 1.0
    v_fma_f32 v234, v234, v234, 1.0
    s_waitcnt lgkmcnt(2)
    v_mfma_f32_32x32x16_bf16 v[64:79], a[136:139], a[100:103], v[64:79]
    ds_read_b64_tr_b16 a[152:153], v51 offset:44032
    ds_read_b64_tr_b16 a[154:155], v51 offset:44288
    buffer_load_dwordx4 v19, s[16:19], s99 offen offset:1024 lds
    buffer_load_dwordx4 a[244:247], v29, s[24:27], s90 offen sc1
    v_fma_f32 v235, v235, v235, 1.0
    v_rcp_f32 v232, v232
    v_rcp_f32 v233, v233
    v_rcp_f32 v234, v234
    v_rcp_f32 v235, v235
    v_fma_f32 v232, v232, v56, v55
    v_fma_f32 v233, v233, v56, v55
    s_waitcnt lgkmcnt(2)
    v_mfma_f32_32x32x16_bf16 v[64:79], a[144:147], a[104:107], v[64:79]
    ds_read_b64_tr_b16 a[128:129], v51 offset:45056
    ds_read_b64_tr_b16 a[130:131], v51 offset:45312
    buffer_load_dwordx4 a[248:251], v28, s[24:27], s91 offen sc1
    v_fma_f32 v234, v234, v56, v55
    v_fma_f32 v235, v235, v56, v55
    v_mul_f32 v232, v184, v232
    v_mul_f32 v233, v185, v233
    v_mul_f32 v234, v186, v234
    v_mul_f32 v235, v187, v235
    v_cvt_pk_bf16_f32 v252, v232, v233
    v_cvt_pk_bf16_f32 v253, v234, v235
    v_mul_f32 v236, s51, v188
    v_mul_f32 v237, s51, v189
    v_mul_f32 v238, s51, v190
    v_mul_f32 v239, s51, v191
    s_add_u32 m0, s59, 147456
    s_waitcnt lgkmcnt(2)
    v_mfma_f32_32x32x16_bf16 v[64:79], a[152:155], a[108:111], v[64:79]
    ds_read_b64_tr_b16 a[136:137], v51 offset:46080
    ds_read_b64_tr_b16 a[138:139], v51 offset:46336
    buffer_load_dwordx4 v20, s[16:19], s94 offen lds
    v_exp_f32 v236, v236
    v_exp_f32 v237, v237
    v_exp_f32 v238, v238
    v_exp_f32 v239, v239
    v_add_f32 v236, 1.0, v236
    v_add_f32 v237, 1.0, v237
    v_add_f32 v238, 1.0, v238
    s_waitcnt lgkmcnt(2)
    v_mfma_f32_32x32x16_bf16 v[64:79], a[128:131], a[112:115], v[64:79]
    ds_read_b64_tr_b16 a[144:145], v51 offset:47104
    ds_read_b64_tr_b16 a[146:147], v51 offset:47360
    buffer_load_dwordx4 a[252:255], v29, s[24:27], s91 offen sc1
    v_add_f32 v239, 1.0, v239
    v_fma_f32 v236, v236, v236, 1.0
    v_fma_f32 v237, v237, v237, 1.0
    v_fma_f32 v238, v238, v238, 1.0
    v_fma_f32 v239, v239, v239, 1.0
    v_rcp_f32 v236, v236
    v_rcp_f32 v237, v237
    v_rcp_f32 v238, v238
    s_waitcnt lgkmcnt(2)
    v_mfma_f32_32x32x16_bf16 v[64:79], a[136:139], a[116:119], v[64:79]
    ds_read_b64_tr_b16 a[152:153], v51 offset:48128
    ds_read_b64_tr_b16 a[154:155], v51 offset:48384
    buffer_load_dwordx4 v21, s[16:19], s94 offen offset:1024 lds
    v_rcp_f32 v239, v239
    v_fma_f32 v236, v236, v56, v55
    v_fma_f32 v237, v237, v56, v55
    v_fma_f32 v238, v238, v56, v55
    v_fma_f32 v239, v239, v56, v55
    v_mul_f32 v236, v188, v236
    v_mul_f32 v237, v189, v237
    v_mul_f32 v238, v190, v238
    v_mul_f32 v239, v191, v239
    v_cvt_pk_bf16_f32 v254, v236, v237
    v_cvt_pk_bf16_f32 v255, v238, v239
    s_waitcnt lgkmcnt(2)
    v_mfma_f32_32x32x16_bf16 v[64:79], a[144:147], a[120:123], v[64:79]
    s_add_u32 m0, s59, 149504
    v_mfma_f32_32x32x16_bf16 v[64:79], a[180:183], a[186:189], v[64:79]
    buffer_load_dwordx4 v20, s[16:19], s95 offen lds
    s_waitcnt lgkmcnt(0)
    v_mfma_f32_32x32x16_bf16 v[64:79], a[152:155], a[124:127], v[64:79]
    s_waitcnt vmcnt(26)
    v_mfma_f32_32x32x16_bf16 a[48:63], v[132:135], a[196:199], 0
    buffer_load_dwordx4 v21, s[16:19], s95 offen offset:1024 lds
    s_add_u32 m0, s59, 65536
    v_mfma_f32_32x32x16_bf16 a[32:47], v[128:131], a[196:199], 0
    buffer_load_dwordx4 v20, s[16:19], s96 offen lds
    buffer_load_dwordx4 v21, s[16:19], s96 offen offset:1024 lds
    s_nop 4
    v_mul_f32 v232, s51, v64
    v_mul_f32 v233, s51, v65
    v_mul_f32 v234, s51, v66
    v_mul_f32 v235, s51, v67
    v_exp_f32 v232, v232
    v_exp_f32 v233, v233
    v_exp_f32 v234, v234
    v_exp_f32 v235, v235
    v_add_f32 v232, 1.0, v232
    v_add_f32 v233, 1.0, v233
    v_add_f32 v234, 1.0, v234
    v_add_f32 v235, 1.0, v235
    v_fma_f32 v232, v232, v232, 1.0
    v_fma_f32 v233, v233, v233, 1.0
    v_fma_f32 v234, v234, v234, 1.0
    v_fma_f32 v235, v235, v235, 1.0
    v_rcp_f32 v232, v232
    v_rcp_f32 v233, v233
    v_rcp_f32 v234, v234
    v_rcp_f32 v235, v235
    v_fma_f32 v232, v232, v56, v55
    v_fma_f32 v233, v233, v56, v55
    v_fma_f32 v234, v234, v56, v55
    v_fma_f32 v235, v235, v56, v55
    v_mul_f32 v232, v64, v232
    v_mul_f32 v233, v65, v233
    v_mul_f32 v234, v66, v234
    v_mul_f32 v235, v67, v235
    v_cvt_pk_bf16_f32 v224, v232, v233
    v_cvt_pk_bf16_f32 v225, v234, v235
    v_mul_f32 v236, s51, v68
    v_mul_f32 v237, s51, v69
    v_mul_f32 v238, s51, v70
    v_mul_f32 v239, s51, v71
    v_exp_f32 v236, v236
    v_exp_f32 v237, v237
    v_exp_f32 v238, v238
    v_exp_f32 v239, v239
    v_add_f32 v236, 1.0, v236
    v_add_f32 v237, 1.0, v237
    v_add_f32 v238, 1.0, v238
    v_add_f32 v239, 1.0, v239
    v_fma_f32 v236, v236, v236, 1.0
    v_fma_f32 v237, v237, v237, 1.0
    v_fma_f32 v238, v238, v238, 1.0
    v_fma_f32 v239, v239, v239, 1.0
    v_rcp_f32 v236, v236
    v_rcp_f32 v237, v237
    v_rcp_f32 v238, v238
    v_rcp_f32 v239, v239
    v_fma_f32 v236, v236, v56, v55
    v_fma_f32 v237, v237, v56, v55
    v_fma_f32 v238, v238, v56, v55
    v_fma_f32 v239, v239, v56, v55
    v_mul_f32 v236, v68, v236
    v_mul_f32 v237, v69, v237
    v_mul_f32 v238, v70, v238
    v_mul_f32 v239, v71, v239
    v_cvt_pk_bf16_f32 v226, v236, v237
    v_cvt_pk_bf16_f32 v227, v238, v239
    v_mul_f32 v232, s51, v72
    v_mul_f32 v233, s51, v73
    v_mul_f32 v234, s51, v74
    v_mul_f32 v235, s51, v75
    v_exp_f32 v232, v232
    v_exp_f32 v233, v233
    v_exp_f32 v234, v234
    v_exp_f32 v235, v235
    v_add_f32 v232, 1.0, v232
    v_add_f32 v233, 1.0, v233
    v_add_f32 v234, 1.0, v234
    v_add_f32 v235, 1.0, v235
    v_fma_f32 v232, v232, v232, 1.0
    v_fma_f32 v233, v233, v233, 1.0
    v_fma_f32 v234, v234, v234, 1.0
    v_fma_f32 v235, v235, v235, 1.0
    v_rcp_f32 v232, v232
    v_rcp_f32 v233, v233
    v_rcp_f32 v234, v234
    v_rcp_f32 v235, v235
    v_fma_f32 v232, v232, v56, v55
    v_fma_f32 v233, v233, v56, v55
    v_fma_f32 v234, v234, v56, v55
    v_fma_f32 v235, v235, v56, v55
    v_mul_f32 v232, v72, v232
    v_mul_f32 v233, v73, v233
    v_mul_f32 v234, v74, v234
    v_mul_f32 v235, v75, v235
    v_cvt_pk_bf16_f32 v228, v232, v233
    v_cvt_pk_bf16_f32 v229, v234, v235
    v_mul_f32 v236, s51, v76
    v_mul_f32 v237, s51, v77
    v_mul_f32 v238, s51, v78
    v_mul_f32 v239, s51, v79
    v_exp_f32 v236, v236
    v_exp_f32 v237, v237
    v_exp_f32 v238, v238
    v_exp_f32 v239, v239
    v_add_f32 v236, 1.0, v236
    v_add_f32 v237, 1.0, v237
    v_add_f32 v238, 1.0, v238
    v_add_f32 v239, 1.0, v239
    v_fma_f32 v236, v236, v236, 1.0
    v_fma_f32 v237, v237, v237, 1.0
    v_fma_f32 v238, v238, v238, 1.0
    v_fma_f32 v239, v239, v239, 1.0
    v_rcp_f32 v236, v236
    v_rcp_f32 v237, v237
    v_rcp_f32 v238, v238
    v_rcp_f32 v239, v239
    v_fma_f32 v236, v236, v56, v55
    v_fma_f32 v237, v237, v56, v55
    v_fma_f32 v238, v238, v56, v55
    v_fma_f32 v239, v239, v56, v55
    v_mul_f32 v236, v76, v236
    v_mul_f32 v237, v77, v237
    v_mul_f32 v238, v78, v238
    v_mul_f32 v239, v79, v239
    v_cvt_pk_bf16_f32 v230, v236, v237
    v_cvt_pk_bf16_f32 v231, v238, v239
    buffer_store_dwordx4 v[240:243], v4, s[24:27], 0 offen offset:0 sc1
    buffer_store_dwordx4 v[244:247], v4, s[24:27], 0 offen offset:1024 sc1
    buffer_store_dwordx4 v[248:251], v4, s[24:27], 0 offen offset:2048 sc1
    buffer_store_dwordx4 v[252:255], v4, s[24:27], 0 offen offset:3072 sc1
    buffer_store_dwordx4 v[224:227], v5, s[24:27], 0 offen offset:0 sc1
    buffer_store_dwordx4 v[228:231], v5, s[24:27], 0 offen offset:1024 sc1
    s_add_u32 m0, s59, 67584
    v_mfma_f32_32x32x16_bf16 a[16:31], v[132:135], a[192:195], 0
    buffer_load_dwordx4 v20, s[16:19], s97 offen lds
    buffer_load_dwordx4 v21, s[16:19], s97 offen offset:1024 lds
    v_mfma_f32_32x32x16_bf16 a[0:15], v[128:131], a[192:195], 0
    s_add_u32 m0, s59, 81920
    s_waitcnt vmcnt(34)
    v_mfma_f32_32x32x16_bf16 a[48:63], v[140:143], a[204:207], a[48:63]
    s_barrier
    s_load_dword s39, s[24:25], s38 offset:4 glc
    buffer_load_dwordx4 v20, s[16:19], s98 offen lds
    buffer_load_dwordx4 v21, s[16:19], s98 offen offset:1024 lds
    s_add_u32 m0, s59, 83968
    v_mfma_f32_32x32x16_bf16 a[32:47], v[136:139], a[204:207], a[32:47]
    buffer_load_dwordx4 v20, s[16:19], s99 offen lds
    buffer_load_dwordx4 v21, s[16:19], s99 offen offset:1024 lds
    s_add_u32 m0, s59, 98304
    v_mfma_f32_32x32x16_bf16 a[16:31], v[140:143], a[200:203], a[16:31]
    buffer_load_dwordx4 v22, s[16:19], s94 offen lds
    buffer_load_dwordx4 v23, s[16:19], s94 offen offset:1024 lds
    s_add_u32 m0, s59, 100352
    v_mfma_f32_32x32x16_bf16 a[0:15], v[136:139], a[200:203], a[0:15]
    buffer_load_dwordx4 v22, s[16:19], s95 offen lds
    buffer_load_dwordx4 v23, s[16:19], s95 offen offset:1024 lds
    s_waitcnt vmcnt(38)
    v_mfma_f32_32x32x16_bf16 a[48:63], v[148:151], a[212:215], a[48:63]
    s_waitcnt vmcnt(34)
    ds_read_b64_tr_b16 a[128:129], v48 offset:0
    ds_read_b64_tr_b16 a[130:131], v48 offset:1024
    v_mfma_f32_32x32x16_bf16 a[32:47], v[144:147], a[212:215], a[32:47]
    ds_read_b64_tr_b16 a[132:133], v49 offset:0
    ds_read_b64_tr_b16 a[134:135], v49 offset:1024
    v_mfma_f32_32x32x16_bf16 a[16:31], v[148:151], a[208:211], a[16:31]
    v_mov_b32 v61, 1
    v_mfma_f32_32x32x16_bf16 a[0:15], v[144:147], a[208:211], a[0:15]
    s_waitcnt vmcnt(10)
    s_mov_b64 exec, 1
    buffer_atomic_add v61, off, s[24:27], s36 offset:8 sc1
    s_mov_b64 exec, -1
    v_mfma_f32_32x32x16_bf16 a[48:63], v[156:159], a[220:223], a[48:63]
    ds_read_b64_tr_b16 a[136:137], v48 offset:2048
    ds_read_b64_tr_b16 a[138:139], v48 offset:3072
    v_mfma_f32_32x32x16_bf16 a[32:47], v[152:155], a[220:223], a[32:47]
    ds_read_b64_tr_b16 a[140:141], v49 offset:2048
    ds_read_b64_tr_b16 a[142:143], v49 offset:3072
    v_mfma_f32_32x32x16_bf16 a[16:31], v[156:159], a[216:219], a[16:31]
    v_mfma_f32_32x32x16_bf16 a[0:15], v[152:155], a[216:219], a[0:15]
    s_waitcnt lgkmcnt(4)
    v_mfma_f32_32x32x16_bf16 a[48:63], a[132:135], a[228:231], a[48:63]
    s_waitcnt lgkmcnt(0)
    s_cmp_lt_u32 s39, 4
    s_cbranch_scc1 L_retry_A_b1
L_back_A_b1:
    ds_read_b64_tr_b16 a[144:145], v44 offset:49152
    ds_read_b64_tr_b16 a[146:147], v44 offset:50176
    buffer_load_dwordx4 a[64:67], v30, s[24:27], s84 offen sc1
    v_mfma_f32_32x32x16_bf16 a[32:47], a[128:131], a[228:231], a[32:47]
    ds_read_b64_tr_b16 a[148:149], v45 offset:49152
    ds_read_b64_tr_b16 a[150:151], v45 offset:50176
    v_mfma_f32_32x32x16_bf16 a[16:31], a[132:135], a[224:227], a[16:31]
    buffer_load_dwordx4 a[68:71], v31, s[24:27], s84 offen sc1
    v_mfma_f32_32x32x16_bf16 a[0:15], a[128:131], a[224:227], a[0:15]
    buffer_load_dwordx4 a[72:75], v30, s[24:27], s85 offen sc1
    v_mfma_f32_32x32x16_bf16 a[48:63], a[140:143], a[236:239], a[48:63]
    ds_read_b64_tr_b16 a[152:153], v44 offset:51200
    ds_read_b64_tr_b16 a[154:155], v44 offset:52224
    v_mfma_f32_32x32x16_bf16 a[32:47], a[136:139], a[236:239], a[32:47]
    ds_read_b64_tr_b16 a[156:157], v45 offset:51200
    ds_read_b64_tr_b16 a[158:159], v45 offset:52224
    buffer_load_dwordx4 a[76:79], v31, s[24:27], s85 offen sc1
    v_mfma_f32_32x32x16_bf16 a[16:31], a[140:143], a[232:235], a[16:31]
    buffer_load_dwordx4 a[80:83], v30, s[24:27], s86 offen sc1
    v_mfma_f32_32x32x16_bf16 a[0:15], a[136:139], a[232:235], a[0:15]
    s_add_u32 m0, s59, 131072
    s_waitcnt lgkmcnt(4)
    v_mfma_f32_32x32x16_bf16 a[48:63], a[148:151], a[244:247], a[48:63]
    ds_read_b64_tr_b16 a[128:129], v46 offset:49152
    ds_read_b64_tr_b16 a[130:131], v46 offset:50176
    buffer_load_dwordx4 v22, s[16:19], s96 offen lds
    buffer_load_dwordx4 v23, s[16:19], s96 offen offset:1024 lds
    buffer_load_dwordx4 a[84:87], v31, s[24:27], s86 offen sc1
    s_add_u32 m0, s59, 133120
    v_mfma_f32_32x32x16_bf16 a[32:47], a[144:147], a[244:247], a[32:47]
    ds_read_b64_tr_b16 a[132:133], v47 offset:49152
    ds_read_b64_tr_b16 a[134:135], v47 offset:50176
    buffer_load_dwordx4 v22, s[16:19], s97 offen lds
    buffer_load_dwordx4 v23, s[16:19], s97 offen offset:1024 lds
    buffer_load_dwordx4 a[88:91], v30, s[24:27], s87 offen sc1
    v_mfma_f32_32x32x16_bf16 a[16:31], a[148:151], a[240:243], a[16:31]
    v_mfma_f32_32x32x16_bf16 a[0:15], a[144:147], a[240:243], a[0:15]
    buffer_load_dwordx4 a[92:95], v31, s[24:27], s87 offen sc1
    s_waitcnt lgkmcnt(4)
    v_mfma_f32_32x32x16_bf16 a[48:63], a[156:159], a[252:255], a[48:63]
    ds_read_b64_tr_b16 a[136:137], v46 offset:51200
    ds_read_b64_tr_b16 a[138:139], v46 offset:52224
    buffer_load_dwordx4 a[96:99], v30, s[24:27], s88 offen sc1
    v_mfma_f32_32x32x16_bf16 a[32:47], a[152:155], a[252:255], a[32:47]
    ds_read_b64_tr_b16 a[140:141], v47 offset:51200
    ds_read_b64_tr_b16 a[142:143], v47 offset:52224
    v_mfma_f32_32x32x16_bf16 a[16:31], a[156:159], a[248:251], a[16:31]
    buffer_load_dwordx4 a[100:103], v31, s[24:27], s88 offen sc1
    v_mfma_f32_32x32x16_bf16 a[0:15], a[152:155], a[248:251], a[0:15]
    buffer_load_dwordx4 a[104:107], v30, s[24:27], s89 offen sc1
    s_add_u32 m0, s59, 49152
    s_waitcnt vmcnt(13) lgkmcnt(4)
    v_mfma_f32_32x32x16_bf16 a[48:63], a[132:135], a[68:71], a[48:63]
    ds_read_b64_tr_b16 a[144:145], v48 offset:16384
    ds_read_b64_tr_b16 a[146:147], v48 offset:17408
    buffer_load_dwordx4 v22, s[16:19], s98 offen lds
    buffer_load_dwordx4 v23, s[16:19], s98 offen offset:1024 lds
    s_add_u32 m0, s59, 51200
    v_mfma_f32_32x32x16_bf16 a[32:47], a[128:131], a[68:71], a[32:47]
    ds_read_b64_tr_b16 a[148:149], v49 offset:16384
    ds_read_b64_tr_b16 a[150:151], v49 offset:17408
    buffer_load_dwordx4 v22, s[16:19], s99 offen lds
    buffer_load_dwordx4 v23, s[16:19], s99 offen offset:1024 lds
    buffer_load_dwordx4 a[108:111], v31, s[24:27], s89 offen sc1
    v_mfma_f32_32x32x16_bf16 a[16:31], a[132:135], a[64:67], a[16:31]
    buffer_load_dwordx4 a[112:115], v30, s[24:27], s90 offen sc1
    v_mfma_f32_32x32x16_bf16 a[0:15], a[128:131], a[64:67], a[0:15]
    s_waitcnt vmcnt(17) lgkmcnt(4)
    v_mfma_f32_32x32x16_bf16 a[48:63], a[140:143], a[76:79], a[48:63]
    ds_read_b64_tr_b16 a[152:153], v48 offset:18432
    ds_read_b64_tr_b16 a[154:155], v48 offset:19456
    buffer_load_dwordx4 a[116:119], v31, s[24:27], s90 offen sc1
    v_mfma_f32_32x32x16_bf16 a[32:47], a[136:139], a[76:79], a[32:47]
    ds_read_b64_tr_b16 a[156:157], v49 offset:18432
    ds_read_b64_tr_b16 a[158:159], v49 offset:19456
    buffer_load_dwordx4 a[120:123], v30, s[24:27], s91 offen sc1
    v_mfma_f32_32x32x16_bf16 a[16:31], a[140:143], a[72:75], a[16:31]
    v_mfma_f32_32x32x16_bf16 a[0:15], a[136:139], a[72:75], a[0:15]
    buffer_load_dwordx4 a[124:127], v31, s[24:27], s91 offen sc1
    s_add_u32 m0, s59, 114688
    s_and_b32 s54, s94, 0xc000
    s_waitcnt vmcnt(16) lgkmcnt(4)
    v_mfma_f32_32x32x16_bf16 a[48:63], a[148:151], a[84:87], a[48:63]
    ds_read_b64_tr_b16 a[128:129], v46 offset:0
    ds_read_b64_tr_b16 a[130:131], v46 offset:1024
    s_load_dword s39, s[24:25], s38 offset:8 glc
    buffer_load_dwordx4 v24, s[16:19], s54 offen lds
    buffer_load_dwordx4 v25, s[16:19], s54 offen offset:1024 lds
    s_add_u32 m0, s59, 116736
    s_and_b32 s54, s95, 0xc000
    v_mfma_f32_32x32x16_bf16 a[32:47], a[144:147], a[84:87], a[32:47]
    ds_read_b64_tr_b16 a[132:133], v47 offset:0
    ds_read_b64_tr_b16 a[134:135], v47 offset:1024
    buffer_load_dwordx4 v24, s[16:19], s54 offen lds
    buffer_load_dwordx4 v25, s[16:19], s54 offen offset:1024 lds
    v_mfma_f32_32x32x16_bf16 a[16:31], a[148:151], a[80:83], a[16:31]
    v_mfma_f32_32x32x16_bf16 a[0:15], a[144:147], a[80:83], a[0:15]
    s_waitcnt vmcnt(16) lgkmcnt(4)
    v_mfma_f32_32x32x16_bf16 a[48:63], a[156:159], a[92:95], a[48:63]
    ds_read_b64_tr_b16 a[136:137], v46 offset:2048
    ds_read_b64_tr_b16 a[138:139], v46 offset:3072
    v_mfma_f32_32x32x16_bf16 a[32:47], a[152:155], a[92:95], a[32:47]
    ds_read_b64_tr_b16 a[140:141], v47 offset:2048
    ds_read_b64_tr_b16 a[142:143], v47 offset:3072
    v_mfma_f32_32x32x16_bf16 a[16:31], a[156:159], a[88:91], a[16:31]
    v_mfma_f32_32x32x16_bf16 a[0:15], a[152:155], a[88:91], a[0:15]
    s_add_u32 m0, s59, 147456
    s_lshl_b32 s54, s86, 4
    s_waitcnt vmcnt(14) lgkmcnt(4)
    v_mfma_f32_32x32x16_bf16 a[48:63], a[132:135], a[100:103], a[48:63]
    ds_read_b64_tr_b16 a[144:145], v46 offset:16384
    ds_read_b64_tr_b16 a[146:147], v46 offset:17408
    buffer_load_dwordx4 v26, s[20:23], s54 offen lds
    buffer_load_dwordx4 v27, s[20:23], s54 offen offset:1024 lds
    s_add_u32 m0, s59, 149504
    s_lshl_b32 s54, s87, 4
    v_mfma_f32_32x32x16_bf16 a[32:47], a[128:131], a[100:103], a[32:47]
    ds_read_b64_tr_b16 a[148:149], v47 offset:16384
    ds_read_b64_tr_b16 a[150:151], v47 offset:17408
    buffer_load_dwordx4 v26, s[20:23], s54 offen lds
    buffer_load_dwordx4 v27, s[20:23], s54 offen offset:1024 lds
    v_mfma_f32_32x32x16_bf16 a[16:31], a[132:135], a[96:99], a[16:31]
    v_mfma_f32_32x32x16_bf16 a[0:15], a[128:131], a[96:99], a[0:15]
    s_waitcnt vmcnt(12) lgkmcnt(4)
    v_mfma_f32_32x32x16_bf16 a[48:63], a[140:143], a[108:111], a[48:63]
    s_waitcnt lgkmcnt(0)
    s_cmp_lt_u32 s39, 4
    s_cbranch_scc1 L_retry_A_a0
L_back_A_a0:
    ds_read_b64_tr_b16 a[152:153], v46 offset:18432
    ds_read_b64_tr_b16 a[154:155], v46 offset:19456
    buffer_load_dwordx4 a[192:195], v32, s[24:27], s84 offen sc1
    v_mfma_f32_32x32x16_bf16 a[32:47], a[136:139], a[108:111], a[32:47]
    ds_read_b64_tr_b16 a[156:157], v47 offset:18432
    ds_read_b64_tr_b16 a[158:159], v47 offset:19456
    v_mfma_f32_32x32x16_bf16 a[16:31], a[140:143], a[104:107], a[16:31]
    buffer_load_dwordx4 a[196:199], v33, s[24:27], s84 offen sc1
    v_mfma_f32_32x32x16_bf16 a[0:15], a[136:139], a[104:107], a[0:15]
    buffer_load_dwordx4 a[200:203], v32, s[24:27], s85 offen sc1
    s_add_u32 m0, s59, 65536
    s_lshl_b32 s54, s88, 4
    s_waitcnt vmcnt(13)
    v_mfma_f32_32x32x16_bf16 a[48:63], a[148:151], a[116:119], a[48:63]
    ds_read_b64_tr_b16 a[128:129], v44 offset:0
    ds_read_b64_tr_b16 a[130:131], v44 offset:1024
    buffer_load_dwordx4 v26, s[20:23], s54 offen lds
    buffer_load_dwordx4 v27, s[20:23], s54 offen offset:1024 lds
    s_add_u32 m0, s59, 67584
    s_lshl_b32 s54, s89, 4
    v_mfma_f32_32x32x16_bf16 a[32:47], a[144:147], a[116:119], a[32:47]
    ds_read_b64_tr_b16 a[132:133], v45 offset:0
    ds_read_b64_tr_b16 a[134:135], v45 offset:1024
    buffer_load_dwordx4 v26, s[20:23], s54 offen lds
    buffer_load_dwordx4 v27, s[20:23], s54 offen offset:1024 lds
    buffer_load_dwordx4 a[204:207], v33, s[24:27], s85 offen sc1
    v_mfma_f32_32x32x16_bf16 a[16:31], a[148:151], a[112:115], a[16:31]
    buffer_load_dwordx4 a[208:211], v32, s[24:27], s86 offen sc1
    v_mfma_f32_32x32x16_bf16 a[0:15], a[144:147], a[112:115], a[0:15]
    s_waitcnt vmcnt(17) lgkmcnt(4)
    v_mfma_f32_32x32x16_bf16 a[48:63], a[156:159], a[124:127], a[48:63]
    ds_read_b64_tr_b16 a[136:137], v44 offset:2048
    ds_read_b64_tr_b16 a[138:139], v44 offset:3072
    buffer_load_dwordx4 a[212:215], v33, s[24:27], s86 offen sc1
    v_mfma_f32_32x32x16_bf16 a[32:47], a[152:155], a[124:127], a[32:47]
    ds_read_b64_tr_b16 a[140:141], v45 offset:2048
    ds_read_b64_tr_b16 a[142:143], v45 offset:3072
    buffer_load_dwordx4 a[216:219], v32, s[24:27], s87 offen sc1
    v_mfma_f32_32x32x16_bf16 a[16:31], a[156:159], a[120:123], a[16:31]
    v_mfma_f32_32x32x16_bf16 a[0:15], a[152:155], a[120:123], a[0:15]
    buffer_load_dwordx4 a[220:223], v33, s[24:27], s87 offen sc1
    s_add_u32 m0, s59, 81920
    s_lshl_b32 s54, s90, 4
    s_waitcnt vmcnt(10) lgkmcnt(4)
    v_mfma_f32_32x32x16_bf16 a[48:63], a[132:135], a[196:199], a[48:63]
    ds_read_b64_tr_b16 a[144:145], v46 offset:32768
    ds_read_b64_tr_b16 a[146:147], v46 offset:33792
    buffer_load_dwordx4 v26, s[20:23], s54 offen lds
    buffer_load_dwordx4 v27, s[20:23], s54 offen offset:1024 lds
    buffer_load_dwordx4 a[224:227], v32, s[24:27], s88 offen sc1
    s_add_u32 m0, s59, 83968
    s_lshl_b32 s54, s91, 4
    v_mfma_f32_32x32x16_bf16 a[32:47], a[128:131], a[196:199], a[32:47]
    ds_read_b64_tr_b16 a[148:149], v47 offset:32768
    ds_read_b64_tr_b16 a[150:151], v47 offset:33792
    buffer_load_dwordx4 v26, s[20:23], s54 offen lds
    buffer_load_dwordx4 v27, s[20:23], s54 offen offset:1024 lds
    v_mfma_f32_32x32x16_bf16 a[16:31], a[132:135], a[192:195], a[16:31]
    buffer_load_dwordx4 a[228:231], v33, s[24:27], s88 offen sc1
    v_mfma_f32_32x32x16_bf16 a[0:15], a[128:131], a[192:195], a[0:15]
    buffer_load_dwordx4 a[232:235], v32, s[24:27], s89 offen sc1
    s_waitcnt vmcnt(11) lgkmcnt(4)
    v_mfma_f32_32x32x16_bf16 a[48:63], a[140:143], a[204:207], a[48:63]
    ds_read_b64_tr_b16 a[152:153], v46 offset:34816
    ds_read_b64_tr_b16 a[154:155], v46 offset:35840
    v_mfma_f32_32x32x16_bf16 a[32:47], a[136:139], a[204:207], a[32:47]
    ds_read_b64_tr_b16 a[156:157], v47 offset:34816
    ds_read_b64_tr_b16 a[158:159], v47 offset:35840
    buffer_load_dwordx4 a[236:239], v33, s[24:27], s89 offen sc1
    v_mfma_f32_32x32x16_bf16 a[16:31], a[140:143], a[200:203], a[16:31]
    buffer_load_dwordx4 a[240:243], v32, s[24:27], s90 offen sc1
    v_mfma_f32_32x32x16_bf16 a[0:15], a[136:139], a[200:203], a[0:15]
    s_waitcnt vmcnt(11) lgkmcnt(4)
    v_mfma_f32_32x32x16_bf16 a[48:63], a[148:151], a[212:215], a[48:63]
    ds_read_b64_tr_b16 a[128:129], v48 offset:0
    ds_read_b64_tr_b16 a[130:131], v48 offset:1024
    buffer_load_dwordx4 a[244:247], v33, s[24:27], s90 offen sc1
    v_mfma_f32_32x32x16_bf16 a[32:47], a[144:147], a[212:215], a[32:47]
    ds_read_b64_tr_b16 a[132:133], v49 offset:0
    ds_read_b64_tr_b16 a[134:135], v49 offset:1024
    buffer_load_dwordx4 a[248:251], v32, s[24:27], s91 offen sc1
    v_mfma_f32_32x32x16_bf16 a[16:31], a[148:151], a[208:211], a[16:31]
    v_mfma_f32_32x32x16_bf16 a[0:15], a[144:147], a[208:211], a[0:15]
    buffer_load_dwordx4 a[252:255], v33, s[24:27], s91 offen sc1
    s_and_b32 s53, s84, 0xc00
    s_waitcnt vmcnt(12) lgkmcnt(4)
    v_mfma_f32_32x32x16_bf16 a[48:63], a[156:159], a[220:223], a[48:63]
    ds_read_b64_tr_b16 a[136:137], v48 offset:2048
    ds_read_b64_tr_b16 a[138:139], v48 offset:3072
    buffer_load_dwordx4 a[64:67], v34, s[24:27], s53 offen sc1
    v_mfma_f32_32x32x16_bf16 a[32:47], a[152:155], a[220:223], a[32:47]
    ds_read_b64_tr_b16 a[140:141], v49 offset:2048
    ds_read_b64_tr_b16 a[142:143], v49 offset:3072
    v_mfma_f32_32x32x16_bf16 a[16:31], a[156:159], a[216:219], a[16:31]
    buffer_load_dwordx4 a[68:71], v35, s[24:27], s53 offen sc1
    s_and_b32 s53, s85, 0xc00
    v_mfma_f32_32x32x16_bf16 a[0:15], a[152:155], a[216:219], a[0:15]
    buffer_load_dwordx4 a[72:75], v34, s[24:27], s53 offen sc1
    s_waitcnt vmcnt(9) lgkmcnt(4)
    v_mfma_f32_32x32x16_bf16 a[48:63], a[132:135], a[228:231], a[48:63]
    ds_read_b64_tr_b16 a[144:145], v44 offset:49152
    ds_read_b64_tr_b16 a[146:147], v44 offset:50176
    v_mfma_f32_32x32x16_bf16 a[32:47], a[128:131], a[228:231], a[32:47]
    ds_read_b64_tr_b16 a[148:149], v45 offset:49152
    ds_read_b64_tr_b16 a[150:151], v45 offset:50176
    buffer_load_dwordx4 a[76:79], v35, s[24:27], s53 offen sc1
    s_and_b32 s53, s86, 0xc00
    v_mfma_f32_32x32x16_bf16 a[16:31], a[132:135], a[224:227], a[16:31]
    buffer_load_dwordx4 a[80:83], v34, s[24:27], s53 offen sc1
    v_mfma_f32_32x32x16_bf16 a[0:15], a[128:131], a[224:227], a[0:15]
    s_waitcnt vmcnt(9) lgkmcnt(4)
    v_mfma_f32_32x32x16_bf16 a[48:63], a[140:143], a[236:239], a[48:63]
    ds_read_b64_tr_b16 a[152:153], v44 offset:51200
    ds_read_b64_tr_b16 a[154:155], v44 offset:52224
    s_load_dword s39, s[24:25], s38 offset:12 glc
    buffer_load_dwordx4 a[84:87], v35, s[24:27], s53 offen sc1
    s_and_b32 s53, s87, 0xc00
    v_mfma_f32_32x32x16_bf16 a[32:47], a[136:139], a[236:239], a[32:47]
    ds_read_b64_tr_b16 a[156:157], v45 offset:51200
    ds_read_b64_tr_b16 a[158:159], v45 offset:52224
    buffer_load_dwordx4 a[88:91], v34, s[24:27], s53 offen sc1
    v_mfma_f32_32x32x16_bf16 a[16:31], a[140:143], a[232:235], a[16:31]
    v_mfma_f32_32x32x16_bf16 a[0:15], a[136:139], a[232:235], a[0:15]
    buffer_load_dwordx4 a[92:95], v35, s[24:27], s53 offen sc1
    s_waitcnt vmcnt(10) lgkmcnt(4)
    v_mfma_f32_32x32x16_bf16 a[48:63], a[148:151], a[244:247], a[48:63]
    ds_read_b64_tr_b16 a[128:129], v44 offset:32768
    ds_read_b64_tr_b16 a[130:131], v44 offset:33792
    v_mfma_f32_32x32x16_bf16 a[32:47], a[144:147], a[244:247], a[32:47]
    ds_read_b64_tr_b16 a[132:133], v45 offset:32768
    ds_read_b64_tr_b16 a[134:135], v45 offset:33792
    v_mfma_f32_32x32x16_bf16 a[16:31], a[148:151], a[240:243], a[16:31]
    v_mfma_f32_32x32x16_bf16 a[0:15], a[144:147], a[240:243], a[0:15]
    s_waitcnt vmcnt(8) lgkmcnt(4)
    v_mfma_f32_32x32x16_bf16 a[48:63], a[156:159], a[252:255], a[48:63]
    ds_read_b64_tr_b16 a[136:137], v44 offset:34816
    ds_read_b64_tr_b16 a[138:139], v44 offset:35840
    v_mfma_f32_32x32x16_bf16 a[32:47], a[152:155], a[252:255], a[32:47]
    ds_read_b64_tr_b16 a[140:141], v45 offset:34816
    ds_read_b64_tr_b16 a[142:143], v45 offset:35840
    v_mfma_f32_32x32x16_bf16 a[16:31], a[156:159], a[248:251], a[16:31]
    v_mfma_f32_32x32x16_bf16 a[0:15], a[152:155], a[248:251], a[0:15]
    s_waitcnt vmcnt(6) lgkmcnt(4)
    v_mfma_f32_32x32x16_bf16 a[48:63], a[132:135], a[68:71], a[48:63]
    s_waitcnt lgkmcnt(0)
    s_cmp_lt_u32 s39, 4
    s_cbranch_scc1 L_retry_A_o
L_back_A_o:
    ds_read_b64_tr_b16 a[144:145], v46 offset:49152
    ds_read_b64_tr_b16 a[146:147], v46 offset:50176
    buffer_load_dwordx4 a[96:99], v36, s[24:27], s84 offen sc1
    v_mfma_f32_32x32x16_bf16 a[32:47], a[128:131], a[68:71], a[32:47]
    ds_read_b64_tr_b16 a[148:149], v47 offset:49152
    ds_read_b64_tr_b16 a[150:151], v47 offset:50176
    v_mfma_f32_32x32x16_bf16 a[16:31], a[132:135], a[64:67], a[16:31]
    buffer_load_dwordx4 a[100:103], v37, s[24:27], s84 offen sc1
    v_mfma_f32_32x32x16_bf16 a[0:15], a[128:131], a[64:67], a[0:15]
    buffer_load_dwordx4 a[104:107], v36, s[24:27], s85 offen sc1
    s_waitcnt vmcnt(7)
    v_mfma_f32_32x32x16_bf16 a[48:63], a[140:143], a[76:79], a[48:63]
    ds_read_b64_tr_b16 a[152:153], v46 offset:51200
    ds_read_b64_tr_b16 a[154:155], v46 offset:52224
    v_mfma_f32_32x32x16_bf16 a[32:47], a[136:139], a[76:79], a[32:47]
    ds_read_b64_tr_b16 a[156:157], v47 offset:51200
    ds_read_b64_tr_b16 a[158:159], v47 offset:52224
    buffer_load_dwordx4 a[108:111], v37, s[24:27], s85 offen sc1
    v_mfma_f32_32x32x16_bf16 a[16:31], a[140:143], a[72:75], a[16:31]
    buffer_load_dwordx4 a[112:115], v36, s[24:27], s86 offen sc1
    v_mfma_f32_32x32x16_bf16 a[0:15], a[136:139], a[72:75], a[0:15]
    s_waitcnt vmcnt(7) lgkmcnt(4)
    v_mfma_f32_32x32x16_bf16 a[48:63], a[148:151], a[84:87], a[48:63]
    ds_read_b64_tr_b16 a[128:129], v44 offset:16384
    ds_read_b64_tr_b16 a[130:131], v44 offset:17408
    buffer_load_dwordx4 a[116:119], v37, s[24:27], s86 offen sc1
    v_and_b32 v88, 15, v0
    v_lshrrev_b32 v2, 5, v0
    v_mfma_f32_32x32x16_bf16 a[32:47], a[144:147], a[84:87], a[32:47]
    ds_read_b64_tr_b16 a[132:133], v45 offset:16384
    ds_read_b64_tr_b16 a[134:135], v45 offset:17408
    buffer_load_dwordx4 a[120:123], v36, s[24:27], s87 offen sc1
    v_xor_b32 v2, v2, v88
    v_lshlrev_b32 v2, 4, v2
    v_lshl_add_u32 v2, v88, 8, v2
    v_mfma_f32_32x32x16_bf16 a[16:31], a[148:151], a[80:83], a[16:31]
    v_add_u32 v2, s59, v2
    v_and_b32 v88, 16, v0
    v_mfma_f32_32x32x16_bf16 a[0:15], a[144:147], a[80:83], a[0:15]
    buffer_load_dwordx4 a[124:127], v37, s[24:27], s87 offen sc1
    v_mov_b32 v89, 0
    v_mov_b32 v90, 32768
    s_waitcnt vmcnt(8) lgkmcnt(4)
    v_mfma_f32_32x32x16_bf16 a[48:63], a[156:159], a[92:95], a[48:63]
    ds_read_b64_tr_b16 a[136:137], v44 offset:18432
    ds_read_b64_tr_b16 a[138:139], v44 offset:19456
    buffer_load_dwordx4 a[192:195], v36, s[24:27], s88 offen sc1
    v_cmp_eq_u32 vcc, 0, v88
    s_nop 1
    v_cndmask_b32 v89, v90, v89, vcc
    v_add_u32 v64, v89, v2
    v_mfma_f32_32x32x16_bf16 a[32:47], a[152:155], a[92:95], a[32:47]
    ds_read_b64_tr_b16 a[140:141], v45 offset:18432
    ds_read_b64_tr_b16 a[142:143], v45 offset:19456
    v_xor_b32 v65, 32, v64
    v_xor_b32 v66, 64, v64
    v_mfma_f32_32x32x16_bf16 a[16:31], a[156:159], a[88:91], a[16:31]
    buffer_load_dwordx4 a[196:199], v37, s[24:27], s88 offen sc1
    v_xor_b32 v67, 96, v64
    v_xor_b32 v68, 128, v64
    v_xor_b32 v69, 160, v64
    v_mfma_f32_32x32x16_bf16 a[0:15], a[152:155], a[88:91], a[0:15]
    buffer_load_dwordx4 a[200:203], v36, s[24:27], s89 offen sc1
    v_xor_b32 v70, 192, v64
    v_xor_b32 v71, 224, v64
    s_waitcnt vmcnt(9) lgkmcnt(4)
    v_mfma_f32_32x32x16_bf16 a[48:63], a[132:135], a[100:103], a[48:63]
    ds_read_b64_tr_b16 a[144:145], v48 offset:16384
    ds_read_b64_tr_b16 a[146:147], v48 offset:17408
    v_mov_b32 v89, 49152
    v_mov_b32 v90, 98304
    v_mfma_f32_32x32x16_bf16 a[32:47], a[128:131], a[100:103], a[32:47]
    ds_read_b64_tr_b16 a[148:149], v49 offset:16384
    ds_read_b64_tr_b16 a[150:151], v49 offset:17408
    buffer_load_dwordx4 a[204:207], v37, s[24:27], s89 offen sc1
    v_cmp_eq_u32 vcc, 0, v88
    s_nop 1
    v_cndmask_b32 v89, v90, v89, vcc
    v_add_u32 v72, v89, v2
    v_mfma_f32_32x32x16_bf16 a[16:31], a[132:135], a[96:99], a[16:31]
    buffer_load_dwordx4 a[208:211], v36, s[24:27], s90 offen sc1
    v_xor_b32 v73, 32, v72
    v_xor_b32 v74, 64, v72
    v_mfma_f32_32x32x16_bf16 a[0:15], a[128:131], a[96:99], a[0:15]
    v_xor_b32 v75, 96, v72
    v_xor_b32 v76, 128, v72
    v_xor_b32 v77, 160, v72
    s_waitcnt vmcnt(9) lgkmcnt(4)
    v_mfma_f32_32x32x16_bf16 a[48:63], a[140:143], a[108:111], a[48:63]
    ds_read_b64_tr_b16 a[152:153], v48 offset:18432
    ds_read_b64_tr_b16 a[154:155], v48 offset:19456
    buffer_load_dwordx4 a[212:215], v37, s[24:27], s90 offen sc1
    v_xor_b32 v78, 192, v72
    v_xor_b32 v79, 224, v72
    v_mfma_f32_32x32x16_bf16 a[32:47], a[136:139], a[108:111], a[32:47]
    ds_read_b64_tr_b16 a[156:157], v49 offset:18432
    ds_read_b64_tr_b16 a[158:159], v49 offset:19456
    buffer_load_dwordx4 a[216:219], v36, s[24:27], s91 offen sc1
    s_and_b32 s48, s50, 1
    v_lshrrev_b32 v88, 3, v0
    v_mfma_f32_32x32x16_bf16 a[16:31], a[140:143], a[104:107], a[16:31]
    v_lshl_add_u32 v88, s48, 3, v88
    v_and_b32 v2, 7, v0
    v_lshlrev_b32 v2, 1, v2
    v_mfma_f32_32x32x16_bf16 a[0:15], a[136:139], a[104:107], a[0:15]
    buffer_load_dwordx4 a[220:223], v37, s[24:27], s91 offen sc1
    v_xor_b32 v2, v2, v88
    v_lshlrev_b32 v2, 4, v2
    s_waitcnt vmcnt(10) lgkmcnt(4)
    v_mfma_f32_32x32x16_bf16 a[48:63], a[148:151], a[116:119], a[48:63]
    ds_read_b64_tr_b16 a[128:129], v46 offset:0
    ds_read_b64_tr_b16 a[130:131], v46 offset:1024
    v_lshl_add_u32 v2, v88, 8, v2
    s_mov_b32 s48, 0
    v_mfma_f32_32x32x16_bf16 a[32:47], a[144:147], a[116:119], a[32:47]
    ds_read_b64_tr_b16 a[132:133], v47 offset:0
    ds_read_b64_tr_b16 a[134:135], v47 offset:1024
    s_cmp_lt_u32 s50, 2
    s_cselect_b32 s48, s48, 32768
    v_add_u32 v80, s48, v2
    v_mfma_f32_32x32x16_bf16 a[16:31], a[148:151], a[112:115], a[16:31]
    v_xor_b32 v81, 16, v80
    s_mov_b32 s48, 49152
    v_mfma_f32_32x32x16_bf16 a[0:15], a[144:147], a[112:115], a[0:15]
    s_cmp_lt_u32 s50, 2
    s_cselect_b32 s48, s48, 98304
    v_add_u32 v82, s48, v2
    s_waitcnt vmcnt(8) lgkmcnt(4)
    v_mfma_f32_32x32x16_bf16 a[48:63], a[156:159], a[124:127], a[48:63]
    ds_read_b64_tr_b16 a[136:137], v46 offset:2048
    ds_read_b64_tr_b16 a[138:139], v46 offset:3072
    v_xor_b32 v83, 16, v82
    s_mov_b32 s48, 32768
    v_mfma_f32_32x32x16_bf16 a[32:47], a[152:155], a[124:127], a[32:47]
    ds_read_b64_tr_b16 a[140:141], v47 offset:2048
    ds_read_b64_tr_b16 a[142:143], v47 offset:3072
    v_mfma_f32_32x32x16_bf16 a[16:31], a[156:159], a[120:123], a[16:31]
    v_mfma_f32_32x32x16_bf16 a[0:15], a[152:155], a[120:123], a[0:15]
    s_waitcnt vmcnt(6) lgkmcnt(4)
    v_mfma_f32_32x32x16_bf16 a[48:63], a[132:135], a[196:199], a[48:63]
    ds_read_b64_tr_b16 a[144:145], v46 offset:16384
    ds_read_b64_tr_b16 a[146:147], v46 offset:17408
    v_mfma_f32_32x32x16_bf16 a[32:47], a[128:131], a[196:199], a[32:47]
    ds_read_b64_tr_b16 a[148:149], v47 offset:16384
    ds_read_b64_tr_b16 a[150:151], v47 offset:17408
    s_waitcnt vmcnt(4) lgkmcnt(4)
    v_mfma_f32_32x32x16_bf16 a[48:63], a[140:143], a[204:207], a[48:63]
    ds_read_b64_tr_b16 a[152:153], v46 offset:18432
    ds_read_b64_tr_b16 a[154:155], v46 offset:19456
    v_mfma_f32_32x32x16_bf16 a[32:47], a[136:139], a[204:207], a[32:47]
    ds_read_b64_tr_b16 a[156:157], v47 offset:18432
    ds_read_b64_tr_b16 a[158:159], v47 offset:19456
    s_waitcnt vmcnt(2) lgkmcnt(4)
    v_mfma_f32_32x32x16_bf16 a[48:63], a[148:151], a[212:215], a[48:63]
    v_mfma_f32_32x32x16_bf16 a[32:47], a[144:147], a[212:215], a[32:47]
    s_waitcnt vmcnt(0) lgkmcnt(0)
    v_mfma_f32_32x32x16_bf16 a[48:63], a[156:159], a[220:223], a[48:63]
    v_mfma_f32_32x32x16_bf16 a[32:47], a[152:155], a[220:223], a[32:47]
    v_mfma_f32_32x32x16_bf16 a[16:31], a[132:135], a[192:195], a[16:31]
    v_mfma_f32_32x32x16_bf16 a[0:15], a[128:131], a[192:195], a[0:15]
    s_nop 8
    ds_write_b128 v76, a[48:51]
    ds_write_b128 v77, a[52:55]
    v_mfma_f32_32x32x16_bf16 a[16:31], a[140:143], a[200:203], a[16:31]
    ds_write_b128 v78, a[56:59]
    v_mfma_f32_32x32x16_bf16 a[0:15], a[136:139], a[200:203], a[0:15]
    ds_write_b128 v79, a[60:63]
    ds_write_b128 v72, a[32:35]
    v_mfma_f32_32x32x16_bf16 a[16:31], a[148:151], a[208:211], a[16:31]
    ds_write_b128 v73, a[36:39]
    v_mfma_f32_32x32x16_bf16 a[0:15], a[144:147], a[208:211], a[0:15]
    ds_write_b128 v74, a[40:43]
    ds_write_b128 v75, a[44:47]
    v_mfma_f32_32x32x16_bf16 a[16:31], a[156:159], a[216:219], a[16:31]
    v_mfma_f32_32x32x16_bf16 a[0:15], a[152:155], a[216:219], a[0:15]
    s_waitcnt lgkmcnt(0)
    s_barrier
    ds_read_b128 v[224:227], v82 offset:0
    ds_read_b128 v[228:231], v82 offset:4096
    ds_read_b128 v[232:235], v82 offset:8192
    ds_read_b128 v[236:239], v82 offset:12288
    ds_read_b128 v[240:243], v83 offset:0
    ds_read_b128 v[244:247], v83 offset:4096
    ds_read_b128 v[248:251], v83 offset:8192
    ds_read_b128 v[252:255], v83 offset:12288
    s_waitcnt lgkmcnt(6)
    v_add_f32 v224, v224, v228
    v_add_f32 v225, v225, v229
    v_add_f32 v226, v226, v230
    v_add_f32 v227, v227, v231
    s_waitcnt lgkmcnt(4)
    v_add_f32 v232, v232, v236
    v_add_f32 v233, v233, v237
    v_add_f32 v234, v234, v238
    v_add_f32 v235, v235, v239
    v_add_f32 v224, v224, v232
    v_add_f32 v225, v225, v233
    v_add_f32 v226, v226, v234
    v_add_f32 v227, v227, v235
    v_cvt_pk_bf16_f32 v16, v224, v225
    v_cvt_pk_bf16_f32 v17, v226, v227
    s_waitcnt lgkmcnt(2)
    v_add_f32 v240, v240, v244
    v_add_f32 v241, v241, v245
    v_add_f32 v242, v242, v246
    v_add_f32 v243, v243, v247
    s_waitcnt lgkmcnt(0)
    v_add_f32 v248, v248, v252
    v_add_f32 v249, v249, v253
    v_add_f32 v250, v250, v254
    v_add_f32 v251, v251, v255
    v_add_f32 v240, v240, v248
    v_add_f32 v241, v241, v249
    ds_write_b128 v68, a[16:19]
    ds_write_b128 v69, a[20:23]
    ds_write_b128 v70, a[24:27]
    ds_write_b128 v71, a[28:31]
    ds_write_b128 v64, a[0:3]
    ds_write_b128 v65, a[4:7]
    ds_write_b128 v66, a[8:11]
    ds_write_b128 v67, a[12:15]
    v_add_f32 v242, v242, v250
    v_add_f32 v243, v243, v251
    v_cvt_pk_bf16_f32 v18, v240, v241
    v_cvt_pk_bf16_f32 v19, v242, v243
    buffer_store_dwordx4 v[16:19], v7, s[28:31], s48 offen
    s_waitcnt lgkmcnt(0)
    s_barrier
    ds_read_b128 v[192:195], v80 offset:0
    ds_read_b128 v[196:199], v80 offset:4096
    ds_read_b128 v[200:203], v80 offset:8192
    ds_read_b128 v[204:207], v80 offset:12288
    ds_read_b128 v[208:211], v81 offset:0
    ds_read_b128 v[212:215], v81 offset:4096
    ds_read_b128 v[216:219], v81 offset:8192
    ds_read_b128 v[220:223], v81 offset:12288
    s_waitcnt lgkmcnt(6)
    v_add_f32 v192, v192, v196
    v_add_f32 v193, v193, v197
    v_add_f32 v194, v194, v198
    v_add_f32 v195, v195, v199
    s_waitcnt lgkmcnt(4)
    v_add_f32 v200, v200, v204
    v_add_f32 v201, v201, v205
    v_add_f32 v202, v202, v206
    v_add_f32 v203, v203, v207
    v_add_f32 v192, v192, v200
    v_add_f32 v193, v193, v201
    v_add_f32 v194, v194, v202
    v_add_f32 v195, v195, v203
    v_cvt_pk_bf16_f32 v12, v192, v193
    v_cvt_pk_bf16_f32 v13, v194, v195
    s_waitcnt lgkmcnt(2)
    v_add_f32 v208, v208, v212
    v_add_f32 v209, v209, v213
    v_add_f32 v210, v210, v214
    v_add_f32 v211, v211, v215
    s_waitcnt lgkmcnt(0)
    v_add_f32 v216, v216, v220
    v_add_f32 v217, v217, v221
    v_add_f32 v218, v218, v222
    v_add_f32 v219, v219, v223
    v_add_f32 v208, v208, v216
    v_add_f32 v209, v209, v217
    v_add_f32 v210, v210, v218
    v_add_f32 v211, v211, v219
    v_cvt_pk_bf16_f32 v14, v208, v209
    v_cvt_pk_bf16_f32 v15, v210, v211
    buffer_store_dwordx4 v[12:15], v7, s[28:31], 0 offen
    s_endpgm
L_typeB:
    s_lshl_b32 s48, s53, 8
    s_add_u32 s48, s48, 1536
    s_mul_i32 s49, s50, 57344
    s_add_u32 s49, s48, s49
    v_mul_u32_u24 v8, 3584, v62
    v_add3_u32 v8, v8, v61, s49
    v_add_u32 v9, 27648, v8
    v_add_u32 v10, 128, v8
    v_add_u32 v11, 128, v9
    s_mul_i32 s68, s60, 1792
    s_mul_i32 s69, s61, 1792
    s_cmp_eq_u32 s2, 8
    s_cbranch_scc1 L_lead0
L_lead0_back:
    s_add_u32 m0, s59, 0
    s_nop 0
    buffer_load_dwordx4 v4, s[4:7], s60 offen lds
    buffer_load_dwordx4 v5, s[4:7], s60 offen offset:1024 lds
    buffer_load_dwordx4 v6, s[4:7], s60 offen offset:2048 lds
    buffer_load_dwordx4 v7, s[4:7], s60 offen offset:3072 lds
    s_add_u32 m0, s58, 16384
    s_nop 0
    buffer_load_dwordx4 v8, s[12:15], s68 offen lds
    buffer_load_dwordx4 v9, s[12:15], s68 offen offset:1024 lds
    s_lshl_b32 s49, s50, 9
    s_add_u32 m0, s49, 147456
    s_and_b32 s49, s49, 1023
    s_mov_b32 exec_hi, 0
    buffer_load_dwordx4 v1, s[44:47], s49 offen lds
    s_mov_b32 exec_hi, -1
    s_and_b32 s44, s53, 1
    s_lshl_b32 s100, s53, 7
    s_mul_i32 s70, s62, 1792
    s_mul_i32 s71, s63, 1792
    s_mul_i32 s72, s64, 1792
    s_mul_i32 s73, s65, 1792
    s_mul_i32 s74, s66, 1792
    s_mul_i32 s75, s67, 1792
    v_lshrrev_b32 v208, 5, v0
    v_bfe_u32 v209, v0, 2, 2
    v_and_b32 v210, 16, v0
    v_and_b32 v211, 3, v0
    v_lshlrev_b32 v211, 3, v211
    v_lshl_or_b32 v211, v210, 1, v211
    v_lshrrev_b32 v2, 1, v209
    v_lshl_or_b32 v210, v2, 6, v211
    v_lshl_add_u32 v210, v209, 7, v210
    v_lshl_add_u32 v38, v208, 10, v210
    v_xor_b32 v39, 64, v38
    v_lshl_add_u32 v44, v208, 9, v210
    v_add_u32 v44, s59, v44
    v_xor_b32 v45, 64, v44
    v_add_u32 v40, 65536, v38
    v_add_u32 v41, 65536, v39
    v_add_u32 v46, 65536, v44
    v_add_u32 v47, 65536, v45
    v_add_u32 v42, 131072, v38
    v_add_u32 v43, 131072, v39
    v_add_u32 v48, 131072, v44
    v_add_u32 v49, 131072, v45
    v_bfe_u32 v2, v0, 1, 3
    v_xor_b32 v2, v2, v208
    v_lshlrev_b32 v2, 4, v2
    v_and_b32 v210, 31, v0
    v_lshl_add_u32 v2, v210, 7, v2
    v_add_u32 v160, s59, v2
    v_xor_b32 v161, 32, v160
    v_xor_b32 v162, 64, v160
    v_xor_b32 v163, 96, v160
    v_add_u32 v164, 65536, v160
    v_add_u32 v165, 65536, v161
    v_add_u32 v166, 65536, v162
    v_add_u32 v167, 65536, v163
    v_add_u32 v168, 131072, v160
    v_add_u32 v169, 131072, v161
    v_add_u32 v170, 131072, v162
    v_add_u32 v171, 131072, v163
    v_and_b32 v2, 7, v0
    v_bfe_u32 v210, v0, 4, 1
    v_lshlrev_b32 v53, 4, v208
    s_add_u32 s48, s60, 147456
    v_add_u32 v53, s48, v53
    v_mov_b32 v211, 159808
    v_cmp_eq_u32 vcc, v2, v210
    s_nop 1
    v_cndmask_b32 v53, v211, v53, vcc
    v_add_u32 v2, 159808, v1
    v_mov_b32 v216, 0
    v_mov_b32 v217, 0
    v_mov_b32 v218, 0
    v_mov_b32 v219, 0
    ds_write_b128 v2, v[216:219]
    v_lshl_add_u32 v2, v208, 2, v209
    v_lshlrev_b32 v2, 5, v2
    v_and_b32 v210, 3, v0
    v_lshl_add_u32 v2, v210, 3, v2
    v_and_b32 v210, 16, v0
    v_lshl_add_u32 v2, v210, 5, v2
    v_add_u32 v172, 149504, v2
    v_mov_b32 v2, 0x3f80
    v_cmp_eq_u32 vcc, 0, v208
    s_nop 1
    v_cndmask_b32 v2, 0, v2, vcc
    v_accvgpr_write_b32 a186, v2
    v_accvgpr_write_b32 a187, 0
    v_accvgpr_write_b32 a188, 0
    v_accvgpr_write_b32 a189, 0
    v_accvgpr_write_b32 a177, 0
    v_accvgpr_write_b32 a179, 0
    v_accvgpr_write_b32 a181, 0
    v_accvgpr_write_b32 a183, 0
    v_accvgpr_write_b32 a184, 0
    v_accvgpr_write_b32 a185, 0
    s_mul_i32 s76, s60, 1536
    s_mul_i32 s77, s61, 1536
    s_mul_i32 s78, s62, 1536
    s_mul_i32 s79, s63, 1536
    s_mul_i32 s80, s64, 1536
    s_mul_i32 s81, s65, 1536
    s_mul_i32 s82, s66, 1536
    s_mul_i32 s83, s67, 1536
    s_mul_i32 s49, s50, 49152
    s_add_u32 s49, s49, s100
    v_mul_u32_u24 v12, 3072, v62
    v_add3_u32 v12, v12, v61, s49
    v_add_u32 v13, 23552, v12
    s_add_u32 s48, s3, 0
    s_and_b32 s48, s48, 7
    s_lshl_b32 s84, s48, 10
    s_and_b32 s48, s48, 4
    s_lshl_b32 s48, s48, 14
    s_lshl4_add_u32 s92, s84, s48
    s_add_u32 s48, s3, 1
    s_and_b32 s48, s48, 7
    s_lshl_b32 s85, s48, 10
    s_and_b32 s48, s48, 4
    s_lshl_b32 s48, s48, 14
    s_lshl4_add_u32 s93, s85, s48
    s_add_u32 s48, s3, 2
    s_and_b32 s48, s48, 7
    s_lshl_b32 s86, s48, 10
    s_and_b32 s48, s48, 4
    s_lshl_b32 s48, s48, 14
    s_lshl4_add_u32 s94, s86, s48
    s_add_u32 s48, s3, 3
    s_and_b32 s48, s48, 7
    s_lshl_b32 s87, s48, 10
    s_and_b32 s48, s48, 4
    s_lshl_b32 s48, s48, 14
    s_lshl4_add_u32 s95, s87, s48
    s_add_u32 s48, s3, 4
    s_and_b32 s48, s48, 7
    s_lshl_b32 s88, s48, 10
    s_and_b32 s48, s48, 4
    s_lshl_b32 s48, s48, 14
    s_lshl4_add_u32 s96, s88, s48
    s_add_u32 s48, s3, 5
    s_and_b32 s48, s48, 7
    s_lshl_b32 s89, s48, 10
    s_and_b32 s48, s48, 4
    s_lshl_b32 s48, s48, 14
    s_lshl4_add_u32 s97, s89, s48
    s_add_u32 s48, s3, 6
    s_and_b32 s48, s48, 7
    s_lshl_b32 s90, s48, 10
    s_and_b32 s48, s48, 4
    s_lshl_b32 s48, s48, 14
    s_lshl4_add_u32 s98, s90, s48
    s_add_u32 s48, s3, 7
    s_and_b32 s48, s48, 7
    s_lshl_b32 s91, s48, 10
    s_and_b32 s48, s48, 4
    s_lshl_b32 s48, s48, 14
    s_lshl4_add_u32 s99, s91, s48
    v_lshl_add_u32 v2, v62, 10, v61
    v_lshl_add_u32 v2, s55, 7, v2
    s_lshl_b32 s48, s50, 18
    s_add_u32 s48, s48, 786432
    v_add_u32 v18, s48, v2
    v_add_u32 v20, 65536, v18
    s_mul_i32 s48, s50, 196608
    v_add_u32 v22, s48, v2
    v_add_u32 v24, 65536, v22
    v_lshl_add_u32 v26, s50, 17, v2
    v_add_u32 v19, 7168, v18
    v_add_u32 v21, 7168, v20
    v_add_u32 v23, 7168, v22
    v_add_u32 v25, 7168, v24
    v_add_u32 v27, 7168, v26
    s_mul_i32 s48, s54, 294912
    s_mul_i32 s49, s50, 36864
    s_add_u32 s48, s48, s49
    s_add_u32 s48, s48, 655360
    v_add_u32 v28, s48, v1
    v_add_u32 v29, 147456, v28
    v_add_u32 v30, 8192, v28
    v_add_u32 v31, 155648, v28
    v_add_u32 v32, 16384, v28
    v_add_u32 v33, 163840, v28
    v_add_u32 v34, 24576, v28
    v_add_u32 v35, 172032, v28
    v_add_u32 v36, 28672, v28
    v_add_u32 v37, 176128, v28
    s_lshl2_add_u32 s48, s51, s50
    s_mul_i32 s48, s48, 147456
    s_lshr_b32 s49, s53, 1
    s_mul_i32 s49, s49, 36864
    s_add_u32 s48, s48, s49
    s_lshl_b32 s49, s44, 12
    s_add_u32 s48, s48, s49
    s_add_u32 s48, s48, 655360
    v_add_u32 v61, s48, v1
    s_lshl3_add_u32 s48, s54, s50
    s_lshl_b32 s48, s48, 6
    s_add_u32 s48, s48, s55
    s_lshl_b32 s48, s48, 7
    v_and_b32 v2, 7, v0
    v_lshlrev_b32 v2, 4, v2
    v_lshl_add_u32 v2, v62, 10, v2
    v_add_u32 v59, s48, v2
    s_lshl2_add_u32 s48, s53, s50
    s_lshl_b32 s48, s48, 4
    s_lshl2_add_u32 s49, s51, s50
    s_lshl_b32 s49, s49, 7
    s_add_u32 s49, s49, 32768
    v_and_b32 v2, 31, v0
    v_lshl_add_u32 v14, v2, 2, s49
    v_lshrrev_b32 v2, 2, v0
    v_mov_b32 v15, 0x7ff00000
    v_cmp_eq_u32 vcc, s53, v2
    s_nop 1
    v_cndmask_b32 v14, v15, v14, vcc
    s_lshl_b32 s49, s48, 10
    s_add_u32 s49, s49, 131072
    v_add_u32 v52, s49, v1
    s_lshl_b32 s49, s48, 7
    s_add_u32 s49, s49, 65536
    v_and_b32 v2, 31, v0
    v_lshl_add_u32 v50, v2, 2, s49
    v_lshl_add_u32 v50, v208, 10, v50
    v_add_u32 v51, 151552, v1
    s_lshl_b32 s48, s53, 6
    s_add_u32 s48, s48, s50
    s_lshl_b32 s48, s48, 2
    v_and_b32 v2, 15, v0
    v_lshl_add_u32 v58, v2, 11, s48
    s_movk_i32 s56, 0x3f80
    v_bfe_u32 v212, v0, 2, 1
    v_xor_b32 v212, v212, v208
    v_bfe_u32 v213, v0, 4, 1
    v_or_b32 v212, v212, v213
    v_bfe_u32 v213, v0, 3, 1
    v_lshlrev_b32 v213, 1, v213
    v_bfe_u32 v2, v0, 1, 1
    v_or_b32 v213, v213, v2
    v_lshl_or_b32 v212, v212, 2, v213
    v_and_b32 v213, 1, v0
    v_lshlrev_b32 v213, 4, v213
    v_lshlrev_b32 v213, v213, s56
    v_cmp_eq_u32 vcc, 0, v212
    s_nop 1
    v_cndmask_b32 v2, 0, v213, vcc
    v_accvgpr_write_b32 a160, v2
    v_cmp_eq_u32 vcc, 1, v212
    s_nop 1
    v_cndmask_b32 v2, 0, v213, vcc
    v_accvgpr_write_b32 a161, v2
    v_cmp_eq_u32 vcc, 2, v212
    s_nop 1
    v_cndmask_b32 v2, 0, v213, vcc
    v_accvgpr_write_b32 a162, v2
    v_cmp_eq_u32 vcc, 3, v212
    s_nop 1
    v_cndmask_b32 v2, 0, v213, vcc
    v_accvgpr_write_b32 a163, v2
    v_lshrrev_b32 v212, 4, v0
    v_and_b32 v213, 8, v0
    v_lshlrev_b32 v213, 1, v213
    v_lshlrev_b32 v213, v213, s56
    v_cmp_eq_u32 vcc, 1, v212
    s_nop 1
    v_cndmask_b32 v2, 0, v213, vcc
    v_accvgpr_write_b32 a164, v2
    v_accvgpr_write_b32 a165, 0
    v_accvgpr_write_b32 a166, 0
    v_accvgpr_write_b32 a167, 0
    s_add_u32 m0, s59, 32768
    s_nop 0
    buffer_load_dwordx4 v4, s[4:7], s61 offen lds
    buffer_load_dwordx4 v5, s[4:7], s61 offen offset:1024 lds
    buffer_load_dwordx4 v6, s[4:7], s61 offen offset:2048 lds
    buffer_load_dwordx4 v7, s[4:7], s61 offen offset:3072 lds
    s_add_u32 m0, s58, 24576
    s_nop 0
    buffer_load_dwordx4 v8, s[12:15], s69 offen lds
    buffer_load_dwordx4 v9, s[12:15], s69 offen offset:1024 lds
    v_and_b32 v214, 31, v0
    v_lshlrev_b32 v214, 1, v214
    s_lshl_b32 s49, s50, 9
    s_add_u32 m0, s49, 149504
    s_lshl_b32 s47, s53, 11
    s_add_u32 s49, s49, s47
    s_mov_b32 exec_hi, 0
    buffer_load_dwordx4 v1, s[36:39], s49 offen lds
    s_mov_b32 exec_hi, -1
    s_lshl_b32 s49, s53, 8
    s_add_u32 s49, s49, 1536
    buffer_load_ushort a176, v214, s[40:43], s49 offen offset:0
    buffer_load_ushort a178, v214, s[40:43], s49 offen offset:64
    buffer_load_ushort a180, v214, s[40:43], s49 offen offset:128
    buffer_load_ushort a182, v214, s[40:43], s49 offen offset:192
    s_mov_b32 s41, 1
    s_lshr_b32 s36, s50, 1
    s_lshl1_add_u32 s36, s51, s36
    s_lshr_b32 s37, s52, 2
    s_lshl2_add_u32 s36, s36, s37
    s_lshl_b32 s36, s36, 7
    s_lshl2_add_u32 s37, s53, s50
    s_add_u32 s37, s37, 128
    s_lshl_b32 s37, s37, 7
    s_lshl2_add_u32 s38, s54, s50
    s_lshl_b32 s38, s38, 7
    s_lshl_b32 s49, s44, 11
    s_sub_u32 s53, 8192, s49
    s_mov_b32 s51, 0x3fb8aa3b
    s_mov_b32 s52, 0
    s_waitcnt lgkmcnt(0)
    s_waitcnt vmcnt(14)
    s_waitcnt vmcnt(12)
    s_waitcnt vmcnt(11)
    s_barrier
    s_cmp_eq_u32 s57, 0
    s_cbranch_scc1 L_lead2
L_lead2_back:
    ds_read_b128 v[132:135], v53 offset:0
    ds_read_b128 a[0:3], v160 offset:0
    ds_read_b64_tr_b16 a[128:129], v38 offset:16384
    ds_read_b64_tr_b16 a[130:131], v38 offset:16896
    ds_read_b64_tr_b16 a[132:133], v39 offset:16384
    ds_read_b64_tr_b16 a[134:135], v39 offset:16896
    ds_read_b128 v[136:139], v53 offset:32
    ds_read_b128 a[4:7], v161 offset:0
    ds_read_b64_tr_b16 a[136:137], v38 offset:18432
    ds_read_b64_tr_b16 a[138:139], v38 offset:18944
    ds_read_b64_tr_b16 a[140:141], v39 offset:18432
    ds_read_b64_tr_b16 a[142:143], v39 offset:18944
    s_waitcnt lgkmcnt(6)
    v_mfma_f32_32x32x16_bf16 v[80:95], a[132:135], a[0:3], 0
    ds_read_b128 v[140:143], v53 offset:64
    ds_read_b128 a[8:11], v162 offset:0
    s_add_u32 m0, s59, 49152
    s_nop 0
    buffer_load_dwordx4 v4, s[4:7], s62 offen lds
    v_mfma_f32_32x32x16_bf16 v[64:79], a[128:131], a[0:3], 0
    ds_read_b64_tr_b16 a[144:145], v38 offset:20480
    ds_read_b64_tr_b16 a[146:147], v38 offset:20992
    buffer_load_dwordx4 v5, s[4:7], s62 offen offset:1024 lds
    v_mfma_f32_16x16x32_bf16 v[128:131], v[132:135], a[0:3], 0
    ds_read_b64_tr_b16 a[148:149], v39 offset:20480
    ds_read_b64_tr_b16 a[150:151], v39 offset:20992
    s_waitcnt lgkmcnt(6)
    v_mfma_f32_32x32x16_bf16 v[80:95], a[140:143], a[4:7], v[80:95]
    ds_read_b128 v[144:147], v53 offset:96
    ds_read_b128 a[12:15], v163 offset:0
    buffer_load_dwordx4 v6, s[4:7], s62 offen offset:2048 lds
    v_mfma_f32_32x32x16_bf16 v[64:79], a[136:139], a[4:7], v[64:79]
    ds_read_b64_tr_b16 a[152:153], v38 offset:22528
    ds_read_b64_tr_b16 a[154:155], v38 offset:23040
    buffer_load_dwordx4 v7, s[4:7], s62 offen offset:3072 lds
    s_add_u32 m0, s58, 65536
    v_mfma_f32_16x16x32_bf16 v[128:131], v[136:139], a[4:7], v[128:131]
    ds_read_b64_tr_b16 a[156:157], v39 offset:22528
    ds_read_b64_tr_b16 a[158:159], v39 offset:23040
    s_waitcnt lgkmcnt(6)
    v_mfma_f32_32x32x16_bf16 v[80:95], a[148:151], a[8:11], v[80:95]
    s_waitcnt vmcnt(11)
    s_waitcnt vmcnt(9)
    s_waitcnt lgkmcnt(0)
    s_barrier
    ds_read_b128 v[132:135], v53 offset:128
    ds_read_b128 a[16:19], v160 offset:32768
    buffer_load_dwordx4 v8, s[12:15], s70 offen lds
    v_mfma_f32_32x32x16_bf16 v[64:79], a[144:147], a[8:11], v[64:79]
    ds_read_b64_tr_b16 a[128:129], v38 offset:24576
    ds_read_b64_tr_b16 a[130:131], v38 offset:25088
    buffer_load_dwordx4 v9, s[12:15], s70 offen offset:1024 lds
    s_add_u32 m0, s58, 73728
    v_mfma_f32_16x16x32_bf16 v[128:131], v[140:143], a[8:11], v[128:131]
    ds_read_b64_tr_b16 a[132:133], v39 offset:24576
    ds_read_b64_tr_b16 a[134:135], v39 offset:25088
    v_mfma_f32_32x32x16_bf16 v[80:95], a[156:159], a[12:15], v[80:95]
    ds_read_b128 v[136:139], v53 offset:160
    ds_read_b128 a[20:23], v161 offset:32768
    buffer_load_dwordx4 v8, s[12:15], s71 offen lds
    v_mfma_f32_32x32x16_bf16 v[64:79], a[152:155], a[12:15], v[64:79]
    ds_read_b64_tr_b16 a[136:137], v38 offset:26624
    ds_read_b64_tr_b16 a[138:139], v38 offset:27136
    buffer_load_dwordx4 v9, s[12:15], s71 offen offset:1024 lds
    s_add_u32 m0, s59, 81920
    v_mfma_f32_16x16x32_bf16 v[128:131], v[144:147], a[12:15], v[128:131]
    ds_read_b64_tr_b16 a[140:141], v39 offset:26624
    ds_read_b64_tr_b16 a[142:143], v39 offset:27136
    s_waitcnt lgkmcnt(6)
    v_mfma_f32_32x32x16_bf16 v[80:95], a[132:135], a[16:19], v[80:95]
    ds_read_b128 v[140:143], v53 offset:192
    ds_read_b128 a[24:27], v162 offset:32768
    buffer_load_dwordx4 v4, s[4:7], s63 offen lds
    v_mfma_f32_32x32x16_bf16 v[64:79], a[128:131], a[16:19], v[64:79]
    ds_read_b64_tr_b16 a[144:145], v38 offset:28672
    ds_read_b64_tr_b16 a[146:147], v38 offset:29184
    buffer_load_dwordx4 v5, s[4:7], s63 offen offset:1024 lds
    v_mfma_f32_16x16x32_bf16 v[128:131], v[132:135], a[16:19], v[128:131]
    ds_read_b64_tr_b16 a[148:149], v39 offset:28672
    ds_read_b64_tr_b16 a[150:151], v39 offset:29184
    s_waitcnt lgkmcnt(6)
    v_mfma_f32_32x32x16_bf16 v[80:95], a[140:143], a[20:23], v[80:95]
    ds_read_b128 v[144:147], v53 offset:224
    ds_read_b128 a[28:31], v163 offset:32768
    buffer_load_dwordx4 v6, s[4:7], s63 offen offset:2048 lds
    v_mfma_f32_32x32x16_bf16 v[64:79], a[136:139], a[20:23], v[64:79]
    ds_read_b64_tr_b16 a[152:153], v38 offset:30720
    ds_read_b64_tr_b16 a[154:155], v38 offset:31232
    buffer_load_dwordx4 v7, s[4:7], s63 offen offset:3072 lds
    s_add_u32 m0, s59, 98304
    v_mfma_f32_16x16x32_bf16 v[128:131], v[136:139], a[20:23], v[128:131]
    ds_read_b64_tr_b16 a[156:157], v39 offset:30720
    ds_read_b64_tr_b16 a[158:159], v39 offset:31232
    s_waitcnt lgkmcnt(6)
    v_mfma_f32_32x32x16_bf16 v[80:95], a[148:151], a[24:27], v[80:95]
    s_waitcnt vmcnt(8)
    s_waitcnt vmcnt(6)
    s_waitcnt lgkmcnt(0)
    s_barrier
    ds_read_b64_tr_b16 a[168:169], v172 offset:0
    ds_read_b64_tr_b16 a[170:171], v172 offset:256
    ds_read_b64_tr_b16 a[172:173], v172 offset:1024
    ds_read_b64_tr_b16 a[174:175], v172 offset:1280
    ds_read_b128 v[132:135], v53 offset:256
    ds_read_b128 a[32:35], v160 offset:49152
    buffer_load_dwordx4 v4, s[4:7], s64 offen lds
    v_mfma_f32_32x32x16_bf16 v[64:79], a[144:147], a[24:27], v[64:79]
    ds_read_b64_tr_b16 a[128:129], v40 offset:0
    ds_read_b64_tr_b16 a[130:131], v40 offset:512
    buffer_load_dwordx4 v5, s[4:7], s64 offen offset:1024 lds
    v_mfma_f32_16x16x32_bf16 v[128:131], v[140:143], a[24:27], v[128:131]
    ds_read_b64_tr_b16 a[132:133], v41 offset:0
    ds_read_b64_tr_b16 a[134:135], v41 offset:512
    v_mfma_f32_32x32x16_bf16 v[80:95], a[156:159], a[28:31], v[80:95]
    ds_read_b128 v[136:139], v53 offset:288
    ds_read_b128 a[36:39], v161 offset:49152
    buffer_load_dwordx4 v6, s[4:7], s64 offen offset:2048 lds
    v_mfma_f32_32x32x16_bf16 v[64:79], a[152:155], a[28:31], v[64:79]
    ds_read_b64_tr_b16 a[136:137], v40 offset:2048
    ds_read_b64_tr_b16 a[138:139], v40 offset:2560
    buffer_load_dwordx4 v7, s[4:7], s64 offen offset:3072 lds
    s_add_u32 m0, s58, 114688
    v_mfma_f32_16x16x32_bf16 v[128:131], v[144:147], a[28:31], v[128:131]
    ds_read_b64_tr_b16 a[140:141], v41 offset:2048
    ds_read_b64_tr_b16 a[142:143], v41 offset:2560
    s_waitcnt lgkmcnt(6)
    v_mfma_f32_32x32x16_bf16 v[80:95], a[132:135], a[32:35], v[80:95]
    ds_read_b128 v[140:143], v53 offset:320
    ds_read_b128 a[40:43], v162 offset:49152
    buffer_load_dwordx4 v8, s[12:15], s72 offen lds
    v_mfma_f32_32x32x16_bf16 v[64:79], a[128:131], a[32:35], v[64:79]
    ds_read_b64_tr_b16 a[144:145], v40 offset:4096
    ds_read_b64_tr_b16 a[146:147], v40 offset:4608
    buffer_load_dwordx4 v9, s[12:15], s72 offen offset:1024 lds
    s_add_u32 m0, s58, 122880
    v_mfma_f32_16x16x32_bf16 v[128:131], v[132:135], a[32:35], v[128:131]
    ds_read_b64_tr_b16 a[148:149], v41 offset:4096
    ds_read_b64_tr_b16 a[150:151], v41 offset:4608
    s_waitcnt lgkmcnt(6)
    v_mfma_f32_32x32x16_bf16 v[80:95], a[140:143], a[36:39], v[80:95]
    ds_read_b128 v[144:147], v53 offset:352
    ds_read_b128 a[44:47], v163 offset:49152
    buffer_load_dwordx4 v8, s[12:15], s73 offen lds
    v_mfma_f32_32x32x16_bf16 v[64:79], a[136:139], a[36:39], v[64:79]
    ds_read_b64_tr_b16 a[152:153], v40 offset:6144
    ds_read_b64_tr_b16 a[154:155], v40 offset:6656
    buffer_load_dwordx4 v9, s[12:15], s73 offen offset:1024 lds
    s_add_u32 m0, s59, 131072
    v_mfma_f32_16x16x32_bf16 v[128:131], v[136:139], a[36:39], v[128:131]
    ds_read_b64_tr_b16 a[156:157], v41 offset:6144
    ds_read_b64_tr_b16 a[158:159], v41 offset:6656
    s_waitcnt lgkmcnt(6)
    v_mfma_f32_32x32x16_bf16 v[80:95], a[148:151], a[40:43], v[80:95]
    s_waitcnt vmcnt(8)
    s_waitcnt lgkmcnt(0)
    s_barrier
    ds_read_b128 v[132:135], v53 offset:384
    ds_read_b128 a[48:51], v164 offset:16384
    buffer_load_dwordx4 v4, s[4:7], s65 offen lds
    v_mfma_f32_32x32x16_bf16 v[64:79], a[144:147], a[40:43], v[64:79]
    ds_read_b64_tr_b16 a[128:129], v40 offset:8192
    ds_read_b64_tr_b16 a[130:131], v40 offset:8704
    buffer_load_dwordx4 v5, s[4:7], s65 offen offset:1024 lds
    v_mfma_f32_16x16x32_bf16 v[128:131], v[140:143], a[40:43], v[128:131]
    ds_read_b64_tr_b16 a[132:133], v41 offset:8192
    ds_read_b64_tr_b16 a[134:135], v41 offset:8704
    v_mfma_f32_32x32x16_bf16 v[80:95], a[156:159], a[44:47], v[80:95]
    ds_read_b128 v[136:139], v53 offset:416
    ds_read_b128 a[52:55], v165 offset:16384
    buffer_load_dwordx4 v6, s[4:7], s65 offen offset:2048 lds
    v_mfma_f32_32x32x16_bf16 v[64:79], a[152:155], a[44:47], v[64:79]
    ds_read_b64_tr_b16 a[136:137], v40 offset:10240
    ds_read_b64_tr_b16 a[138:139], v40 offset:10752
    buffer_load_dwordx4 v7, s[4:7], s65 offen offset:3072 lds
    s_add_u32 m0, s59, 0
    v_mfma_f32_16x16x32_bf16 v[128:131], v[144:147], a[44:47], v[128:131]
    ds_read_b64_tr_b16 a[140:141], v41 offset:10240
    ds_read_b64_tr_b16 a[142:143], v41 offset:10752
    s_waitcnt lgkmcnt(6)
    v_mfma_f32_32x32x16_bf16 v[80:95], a[132:135], a[48:51], v[80:95]
    ds_read_b128 v[140:143], v53 offset:448
    ds_read_b128 a[56:59], v166 offset:16384
    buffer_load_dwordx4 v4, s[4:7], s66 offen lds
    v_mfma_f32_32x32x16_bf16 v[64:79], a[128:131], a[48:51], v[64:79]
    ds_read_b64_tr_b16 a[144:145], v40 offset:12288
    ds_read_b64_tr_b16 a[146:147], v40 offset:12800
    buffer_load_dwordx4 v5, s[4:7], s66 offen offset:1024 lds
    v_mfma_f32_16x16x32_bf16 v[128:131], v[132:135], a[48:51], v[128:131]
    ds_read_b64_tr_b16 a[148:149], v41 offset:12288
    ds_read_b64_tr_b16 a[150:151], v41 offset:12800
    s_waitcnt lgkmcnt(6)
    v_mfma_f32_32x32x16_bf16 v[80:95], a[140:143], a[52:55], v[80:95]
    ds_read_b128 v[144:147], v53 offset:480
    ds_read_b128 a[60:63], v167 offset:16384
    buffer_load_dwordx4 v6, s[4:7], s66 offen offset:2048 lds
    v_mfma_f32_32x32x16_bf16 v[64:79], a[136:139], a[52:55], v[64:79]
    ds_read_b64_tr_b16 a[152:153], v40 offset:14336
    ds_read_b64_tr_b16 a[154:155], v40 offset:14848
    buffer_load_dwordx4 v7, s[4:7], s66 offen offset:3072 lds
    s_add_u32 m0, s58, 16384
    v_mfma_f32_16x16x32_bf16 v[128:131], v[136:139], a[52:55], v[128:131]
    ds_read_b64_tr_b16 a[156:157], v41 offset:14336
    ds_read_b64_tr_b16 a[158:159], v41 offset:14848
    s_waitcnt lgkmcnt(6)
    v_mfma_f32_32x32x16_bf16 v[80:95], a[148:151], a[56:59], v[80:95]
    s_waitcnt vmcnt(12)
    s_waitcnt vmcnt(10)
    s_waitcnt lgkmcnt(0)
    s_barrier
    ds_read_b128 v[132:135], v53 offset:512
    ds_read_b128 a[64:67], v164 offset:32768
    buffer_load_dwordx4 v8, s[12:15], s74 offen lds
    v_mfma_f32_32x32x16_bf16 v[64:79], a[144:147], a[56:59], v[64:79]
    ds_read_b64_tr_b16 a[128:129], v40 offset:49152
    ds_read_b64_tr_b16 a[130:131], v40 offset:49664
    buffer_load_dwordx4 v9, s[12:15], s74 offen offset:1024 lds
    s_add_u32 m0, s58, 24576
    v_mfma_f32_16x16x32_bf16 v[128:131], v[140:143], a[56:59], v[128:131]
    ds_read_b64_tr_b16 a[132:133], v41 offset:49152
    ds_read_b64_tr_b16 a[134:135], v41 offset:49664
    v_mfma_f32_32x32x16_bf16 v[80:95], a[156:159], a[60:63], v[80:95]
    ds_read_b128 v[136:139], v53 offset:544
    ds_read_b128 a[68:71], v165 offset:32768
    buffer_load_dwordx4 v8, s[12:15], s75 offen lds
    v_mfma_f32_32x32x16_bf16 v[64:79], a[152:155], a[60:63], v[64:79]
    ds_read_b64_tr_b16 a[136:137], v40 offset:51200
    ds_read_b64_tr_b16 a[138:139], v40 offset:51712
    buffer_load_dwordx4 v9, s[12:15], s75 offen offset:1024 lds
    s_add_u32 m0, s59, 32768
    v_mfma_f32_16x16x32_bf16 v[128:131], v[144:147], a[60:63], v[128:131]
    ds_read_b64_tr_b16 a[140:141], v41 offset:51200
    ds_read_b64_tr_b16 a[142:143], v41 offset:51712
    s_waitcnt lgkmcnt(6)
    v_mfma_f32_32x32x16_bf16 v[80:95], a[132:135], a[64:67], v[80:95]
    ds_read_b128 v[140:143], v53 offset:576
    ds_read_b128 a[72:75], v166 offset:32768
    buffer_load_dwordx4 v4, s[4:7], s67 offen lds
    v_mfma_f32_32x32x16_bf16 v[64:79], a[128:131], a[64:67], v[64:79]
    ds_read_b64_tr_b16 a[144:145], v40 offset:53248
    ds_read_b64_tr_b16 a[146:147], v40 offset:53760
    buffer_load_dwordx4 v5, s[4:7], s67 offen offset:1024 lds
    v_mfma_f32_16x16x32_bf16 v[128:131], v[132:135], a[64:67], v[128:131]
    ds_read_b64_tr_b16 a[148:149], v41 offset:53248
    ds_read_b64_tr_b16 a[150:151], v41 offset:53760
    s_waitcnt lgkmcnt(6)
    v_mfma_f32_32x32x16_bf16 v[80:95], a[140:143], a[68:71], v[80:95]
    ds_read_b128 v[144:147], v53 offset:608
    ds_read_b128 a[76:79], v167 offset:32768
    buffer_load_dwordx4 v6, s[4:7], s67 offen offset:2048 lds
    v_mfma_f32_32x32x16_bf16 v[64:79], a[136:139], a[68:71], v[64:79]
    ds_read_b64_tr_b16 a[152:153], v40 offset:55296
    ds_read_b64_tr_b16 a[154:155], v40 offset:55808
    buffer_load_dwordx4 v7, s[4:7], s67 offen offset:3072 lds
    s_add_u32 m0, s58, 49152
    v_mfma_f32_16x16x32_bf16 v[128:131], v[136:139], a[68:71], v[128:131]
    ds_read_b64_tr_b16 a[156:157], v41 offset:55296
    ds_read_b64_tr_b16 a[158:159], v41 offset:55808
    s_waitcnt lgkmcnt(6)
    v_mfma_f32_32x32x16_bf16 v[80:95], a[148:151], a[72:75], v[80:95]
    s_waitcnt vmcnt(12)
    s_waitcnt lgkmcnt(0)
    s_barrier
    ds_read_b128 v[132:135], v53 offset:640
    ds_read_b128 a[80:83], v168 offset:0
    buffer_load_dwordx4 v10, s[12:15], s68 offen lds
    v_mfma_f32_32x32x16_bf16 v[64:79], a[144:147], a[72:75], v[64:79]
    ds_read_b64_tr_b16 a[128:129], v40 offset:57344
    ds_read_b64_tr_b16 a[130:131], v40 offset:57856
    buffer_load_dwordx4 v11, s[12:15], s68 offen offset:1024 lds
    s_add_u32 m0, s58, 57344
    v_mfma_f32_16x16x32_bf16 v[128:131], v[140:143], a[72:75], v[128:131]
    ds_read_b64_tr_b16 a[132:133], v41 offset:57344
    ds_read_b64_tr_b16 a[134:135], v41 offset:57856
    v_mfma_f32_32x32x16_bf16 v[80:95], a[156:159], a[76:79], v[80:95]
    ds_read_b128 v[136:139], v53 offset:672
    ds_read_b128 a[84:87], v169 offset:0
    buffer_load_dwordx4 v10, s[12:15], s69 offen lds
    v_mfma_f32_32x32x16_bf16 v[64:79], a[152:155], a[76:79], v[64:79]
    ds_read_b64_tr_b16 a[136:137], v40 offset:59392
    ds_read_b64_tr_b16 a[138:139], v40 offset:59904
    buffer_load_dwordx4 v11, s[12:15], s69 offen offset:1024 lds
    v_mfma_f32_16x16x32_bf16 v[128:131], v[144:147], a[76:79], v[128:131]
    ds_read_b64_tr_b16 a[140:141], v41 offset:59392
    ds_read_b64_tr_b16 a[142:143], v41 offset:59904
    s_waitcnt lgkmcnt(6)
    v_mfma_f32_32x32x16_bf16 v[80:95], a[132:135], a[80:83], v[80:95]
    ds_read_b128 v[140:143], v53 offset:704
    ds_read_b128 a[88:91], v170 offset:0
    s_add_u32 m0, s58, 65536
    v_mfma_f32_32x32x16_bf16 v[64:79], a[128:131], a[80:83], v[64:79]
    ds_read_b64_tr_b16 a[144:145], v40 offset:61440
    ds_read_b64_tr_b16 a[146:147], v40 offset:61952
    buffer_load_dwordx4 v10, s[12:15], s70 offen lds
    v_mfma_f32_16x16x32_bf16 v[128:131], v[132:135], a[80:83], v[128:131]
    ds_read_b64_tr_b16 a[148:149], v41 offset:61440
    ds_read_b64_tr_b16 a[150:151], v41 offset:61952
    s_waitcnt lgkmcnt(6)
    v_mfma_f32_32x32x16_bf16 v[80:95], a[140:143], a[84:87], v[80:95]
    ds_read_b128 v[144:147], v53 offset:736
    ds_read_b128 a[92:95], v171 offset:0
    s_lshl2_add_u32 s47, s2, s50
    s_mul_i32 s47, s47, 1792
    v_lshlrev_b32 v152, 7, v0
    s_mov_b64 exec, 0x3fff
    buffer_load_dword v156, v152, s[16:19], s47 offen
    s_mov_b64 exec, -1
    v_mfma_f32_32x32x16_bf16 v[64:79], a[136:139], a[84:87], v[64:79]
    ds_read_b64_tr_b16 a[152:153], v40 offset:63488
    ds_read_b64_tr_b16 a[154:155], v40 offset:64000
    buffer_load_dwordx4 v11, s[12:15], s70 offen offset:1024 lds
    v_mov_b32 v4, v61
    s_lshl2_add_u32 s47, s2, s50
    s_mul_i32 s47, s47, 512
    v_lshlrev_b32 v152, 7, v0
    s_mov_b64 exec, 0xf
    buffer_load_dword v157, v152, s[20:23], s47 offen
    s_mov_b64 exec, -1
    v_mfma_f32_16x16x32_bf16 v[128:131], v[136:139], a[84:87], v[128:131]
    ds_read_b64_tr_b16 a[156:157], v41 offset:63488
    ds_read_b64_tr_b16 a[158:159], v41 offset:64000
    s_waitcnt lgkmcnt(6)
    v_mfma_f32_32x32x16_bf16 v[80:95], a[148:151], a[88:91], v[80:95]
    s_waitcnt vmcnt(16)
    s_waitcnt vmcnt(14)
    s_waitcnt lgkmcnt(0)
    s_barrier
    ds_read_b128 v[132:135], v53 offset:768
    ds_read_b128 a[96:99], v160 offset:0
    s_add_u32 m0, s58, 73728
    v_mfma_f32_32x32x16_bf16 v[64:79], a[144:147], a[88:91], v[64:79]
    ds_read_b64_tr_b16 a[128:129], v38 offset:16384
    ds_read_b64_tr_b16 a[130:131], v38 offset:16896
    buffer_load_dwordx4 v10, s[12:15], s71 offen lds
    v_mfma_f32_16x16x32_bf16 v[128:131], v[140:143], a[88:91], v[128:131]
    ds_read_b64_tr_b16 a[132:133], v39 offset:16384
    ds_read_b64_tr_b16 a[134:135], v39 offset:16896
    v_mfma_f32_32x32x16_bf16 v[80:95], a[156:159], a[92:95], v[80:95]
    ds_read_b128 v[136:139], v53 offset:800
    ds_read_b128 a[100:103], v161 offset:0
    v_mfma_f32_32x32x16_bf16 v[64:79], a[152:155], a[92:95], v[64:79]
    ds_read_b64_tr_b16 a[136:137], v38 offset:18432
    ds_read_b64_tr_b16 a[138:139], v38 offset:18944
    buffer_load_dwordx4 v11, s[12:15], s71 offen offset:1024 lds
    v_mfma_f32_16x16x32_bf16 v[128:131], v[144:147], a[92:95], v[128:131]
    ds_read_b64_tr_b16 a[140:141], v39 offset:18432
    ds_read_b64_tr_b16 a[142:143], v39 offset:18944
    s_waitcnt lgkmcnt(6)
    v_mfma_f32_32x32x16_bf16 v[80:95], a[132:135], a[96:99], v[80:95]
    ds_read_b128 v[140:143], v53 offset:832
    ds_read_b128 a[104:107], v162 offset:0
    buffer_load_dword v62, off, s[32:35], 0 sc1
    s_add_u32 m0, s58, 81920
    v_mfma_f32_32x32x16_bf16 v[64:79], a[128:131], a[96:99], v[64:79]
    ds_read_b64_tr_b16 a[144:145], v38 offset:20480
    ds_read_b64_tr_b16 a[146:147], v38 offset:20992
    buffer_load_dwordx4 v10, s[12:15], s72 offen lds
    v_mov_b32 v7, v59
    v_mfma_f32_16x16x32_bf16 v[128:131], v[132:135], a[96:99], v[128:131]
    ds_read_b64_tr_b16 a[148:149], v39 offset:20480
    ds_read_b64_tr_b16 a[150:151], v39 offset:20992
    s_waitcnt lgkmcnt(6)
    v_mfma_f32_32x32x16_bf16 v[80:95], a[140:143], a[100:103], v[80:95]
    ds_read_b128 v[144:147], v53 offset:864
    ds_read_b128 a[108:111], v163 offset:0
    v_mfma_f32_32x32x16_bf16 v[64:79], a[136:139], a[100:103], v[64:79]
    ds_read_b64_tr_b16 a[152:153], v38 offset:22528
    ds_read_b64_tr_b16 a[154:155], v38 offset:23040
    buffer_load_dwordx4 v11, s[12:15], s72 offen offset:1024 lds
    v_mfma_f32_16x16x32_bf16 v[128:131], v[136:139], a[100:103], v[128:131]
    ds_read_b64_tr_b16 a[156:157], v39 offset:22528
    ds_read_b64_tr_b16 a[158:159], v39 offset:23040
    s_waitcnt lgkmcnt(6)
    v_mfma_f32_32x32x16_bf16 v[80:95], a[148:151], a[104:107], v[80:95]
    s_waitcnt vmcnt(13)
    s_waitcnt lgkmcnt(0)
    s_barrier
    ds_read_b128 v[132:135], v53 offset:896
    ds_read_b128 a[112:115], v160 offset:32768
    s_add_u32 m0, s58, 90112
    v_mfma_f32_32x32x16_bf16 v[64:79], a[144:147], a[104:107], v[64:79]
    ds_read_b64_tr_b16 a[128:129], v38 offset:24576
    ds_read_b64_tr_b16 a[130:131], v38 offset:25088
    buffer_load_dwordx4 v10, s[12:15], s73 offen lds
    v_mfma_f32_16x16x32_bf16 v[128:131], v[140:143], a[104:107], v[128:131]
    ds_read_b64_tr_b16 a[132:133], v39 offset:24576
    ds_read_b64_tr_b16 a[134:135], v39 offset:25088
    v_mfma_f32_32x32x16_bf16 v[80:95], a[156:159], a[108:111], v[80:95]
    ds_read_b128 v[136:139], v53 offset:928
    ds_read_b128 a[116:119], v161 offset:32768
    v_add_u32 v5, 8192, v61
    v_mfma_f32_32x32x16_bf16 v[64:79], a[152:155], a[108:111], v[64:79]
    ds_read_b64_tr_b16 a[136:137], v38 offset:26624
    ds_read_b64_tr_b16 a[138:139], v38 offset:27136
    buffer_load_dwordx4 v11, s[12:15], s73 offen offset:1024 lds
    v_mfma_f32_16x16x32_bf16 v[128:131], v[144:147], a[108:111], v[128:131]
    ds_read_b64_tr_b16 a[140:141], v39 offset:26624
    ds_read_b64_tr_b16 a[142:143], v39 offset:27136
    s_waitcnt lgkmcnt(6)
    v_mfma_f32_32x32x16_bf16 v[80:95], a[132:135], a[112:115], v[80:95]
    ds_read_b128 v[140:143], v53 offset:960
    ds_read_b128 a[120:123], v162 offset:32768
    s_add_u32 m0, s58, 98304
    v_mfma_f32_32x32x16_bf16 v[64:79], a[128:131], a[112:115], v[64:79]
    ds_read_b64_tr_b16 a[144:145], v38 offset:28672
    ds_read_b64_tr_b16 a[146:147], v38 offset:29184
    buffer_load_dwordx4 v10, s[12:15], s74 offen lds
    v_mfma_f32_16x16x32_bf16 v[128:131], v[132:135], a[112:115], v[128:131]
    ds_read_b64_tr_b16 a[148:149], v39 offset:28672
    ds_read_b64_tr_b16 a[150:151], v39 offset:29184
    s_waitcnt lgkmcnt(6)
    v_mfma_f32_32x32x16_bf16 v[80:95], a[140:143], a[116:119], v[80:95]
    ds_read_b128 v[144:147], v53 offset:992
    ds_read_b128 a[124:127], v163 offset:32768
    v_mfma_f32_32x32x16_bf16 v[64:79], a[136:139], a[116:119], v[64:79]
    ds_read_b64_tr_b16 a[152:153], v38 offset:30720
    ds_read_b64_tr_b16 a[154:155], v38 offset:31232
    buffer_load_dwordx4 v11, s[12:15], s74 offen offset:1024 lds
    v_mfma_f32_16x16x32_bf16 v[128:131], v[136:139], a[116:119], v[128:131]
    ds_read_b64_tr_b16 a[156:157], v39 offset:30720
    ds_read_b64_tr_b16 a[158:159], v39 offset:31232
    s_waitcnt lgkmcnt(6)
    v_mfma_f32_32x32x16_bf16 v[80:95], a[148:151], a[120:123], v[80:95]
    s_waitcnt vmcnt(13)
    s_waitcnt lgkmcnt(0)
    s_barrier
    ds_read_b64_tr_b16 a[128:129], v38 offset:49152
    ds_read_b64_tr_b16 a[130:131], v38 offset:49664
    v_add_u32 v6, 28672, v61
    s_add_u32 m0, s58, 106496
    v_mfma_f32_32x32x16_bf16 v[80:95], a[178:181], a[186:189], v[80:95]
    ds_read_b64_tr_b16 a[132:133], v39 offset:49152
    ds_read_b64_tr_b16 a[134:135], v39 offset:49664
    buffer_load_dwordx4 v10, s[12:15], s75 offen lds
    v_mfma_f32_32x32x16_bf16 v[64:79], a[144:147], a[120:123], v[64:79]
    v_mfma_f32_32x32x16_bf16 v[64:79], a[176:179], a[186:189], v[64:79]
    buffer_load_dwordx4 v11, s[12:15], s75 offen offset:1024 lds
    v_mfma_f32_16x16x32_bf16 v[128:131], v[140:143], a[120:123], v[128:131]
    v_mfma_f32_32x32x16_bf16 v[80:95], a[156:159], a[124:127], v[80:95]
    ds_read_b64_tr_b16 a[136:137], v38 offset:51200
    ds_read_b64_tr_b16 a[138:139], v38 offset:51712
    s_add_u32 m0, s58, 114688
    v_mfma_f32_32x32x16_bf16 v[64:79], a[152:155], a[124:127], v[64:79]
    ds_read_b64_tr_b16 a[140:141], v39 offset:51200
    ds_read_b64_tr_b16 a[142:143], v39 offset:51712
    buffer_load_dwordx4 v12, s[8:11], s76 offen lds
    v_mfma_f32_16x16x32_bf16 v[128:131], v[144:147], a[124:127], v[128:131]
    s_waitcnt lgkmcnt(4)
    v_mfma_f32_32x32x16_bf16 v[112:127], a[132:135], a[0:3], 0
    ds_read_b64_tr_b16 a[144:145], v38 offset:53248
    ds_read_b64_tr_b16 a[146:147], v38 offset:53760
    v_mfma_f32_32x32x16_bf16 v[96:111], a[128:131], a[0:3], 0
    ds_read_b64_tr_b16 a[148:149], v39 offset:53248
    ds_read_b64_tr_b16 a[150:151], v39 offset:53760
    buffer_load_dwordx4 v13, s[8:11], s76 offen offset:1024 lds
    s_waitcnt lgkmcnt(4)
    v_mfma_f32_32x32x16_bf16 v[112:127], a[140:143], a[4:7], v[112:127]
    ds_read_b64_tr_b16 a[152:153], v38 offset:55296
    ds_read_b64_tr_b16 a[154:155], v38 offset:55808
    s_add_u32 m0, s58, 122880
    v_mfma_f32_32x32x16_bf16 v[96:111], a[136:139], a[4:7], v[96:111]
    ds_read_b64_tr_b16 a[156:157], v39 offset:55296
    ds_read_b64_tr_b16 a[158:159], v39 offset:55808
    buffer_load_dwordx4 v12, s[8:11], s77 offen lds
    v_permlane16_swap_b32 v128, v129
    v_mul_f32 v54, 0xbfb8aa3b, v128
    v_exp_f32 v54, v54
    s_nop 0
    v_add_f32 v54, 1.0, v54
    v_rcp_f32 v54, v54
    s_nop 0
    v_sub_f32 v55, 1.0, v54
    v_mul_f32 v56, -2.0, v55
    s_waitcnt vmcnt(11)
    v_readfirstlane_b32 s55, v62
    s_nop 0
    s_cmp_eq_u32 s55, 0
    s_cbranch_scc1 L_retry_B_tag
L_back_B_tag:
    s_waitcnt lgkmcnt(4)
    v_mfma_f32_32x32x16_bf16 v[112:127], a[148:151], a[8:11], v[112:127]
    ds_read_b64_tr_b16 a[128:129], v38 offset:57344
    ds_read_b64_tr_b16 a[130:131], v38 offset:57856
    v_mul_f32 v232, s51, v64
    v_mul_f32 v233, s51, v65
    v_mul_f32 v234, s51, v66
    v_mul_f32 v235, s51, v67
    v_exp_f32 v232, v232
    v_exp_f32 v233, v233
    v_exp_f32 v234, v234
    v_exp_f32 v235, v235
    v_mfma_f32_32x32x16_bf16 v[96:111], a[144:147], a[8:11], v[96:111]
    ds_read_b64_tr_b16 a[132:133], v39 offset:57344
    ds_read_b64_tr_b16 a[134:135], v39 offset:57856
    buffer_load_dwordx4 v13, s[8:11], s77 offen offset:1024 lds
    v_add_f32 v232, 1.0, v232
    v_add_f32 v233, 1.0, v233
    v_add_f32 v234, 1.0, v234
    v_add_f32 v235, 1.0, v235
    v_fma_f32 v232, v232, v232, 1.0
    v_fma_f32 v233, v233, v233, 1.0
    v_fma_f32 v234, v234, v234, 1.0
    v_fma_f32 v235, v235, v235, 1.0
    v_rcp_f32 v232, v232
    v_rcp_f32 v233, v233
    s_waitcnt lgkmcnt(4)
    v_mfma_f32_32x32x16_bf16 v[112:127], a[156:159], a[12:15], v[112:127]
    ds_read_b64_tr_b16 a[136:137], v38 offset:59392
    ds_read_b64_tr_b16 a[138:139], v38 offset:59904
    v_rcp_f32 v234, v234
    v_rcp_f32 v235, v235
    v_fma_f32 v232, v232, v56, v55
    v_fma_f32 v233, v233, v56, v55
    v_fma_f32 v234, v234, v56, v55
    v_fma_f32 v235, v235, v56, v55
    v_mul_f32 v232, v64, v232
    v_mul_f32 v233, v65, v233
    v_mul_f32 v234, v66, v234
    s_add_u32 m0, s58, 131072
    v_mfma_f32_32x32x16_bf16 v[96:111], a[152:155], a[12:15], v[96:111]
    ds_read_b64_tr_b16 a[140:141], v39 offset:59392
    ds_read_b64_tr_b16 a[142:143], v39 offset:59904
    buffer_load_dwordx4 v12, s[8:11], s78 offen lds
    v_mul_f32 v235, v67, v235
    v_cvt_pk_bf16_f32 v240, v232, v233
    v_cvt_pk_bf16_f32 v241, v234, v235
    v_mul_f32 v236, s51, v68
    v_mul_f32 v237, s51, v69
    v_mul_f32 v238, s51, v70
    v_mul_f32 v239, s51, v71
    v_exp_f32 v236, v236
    v_exp_f32 v237, v237
    s_waitcnt lgkmcnt(4)
    v_mfma_f32_32x32x16_bf16 v[112:127], a[132:135], a[16:19], v[112:127]
    ds_read_b64_tr_b16 a[144:145], v38 offset:61440
    ds_read_b64_tr_b16 a[146:147], v38 offset:61952
    v_exp_f32 v238, v238
    v_exp_f32 v239, v239
    v_add_f32 v236, 1.0, v236
    v_add_f32 v237, 1.0, v237
    v_add_f32 v238, 1.0, v238
    v_add_f32 v239, 1.0, v239
    v_fma_f32 v236, v236, v236, 1.0
    v_fma_f32 v237, v237, v237, 1.0
    v_fma_f32 v238, v238, v238, 1.0
    v_fma_f32 v239, v239, v239, 1.0
    v_mfma_f32_32x32x16_bf16 v[96:111], a[128:131], a[16:19], v[96:111]
    ds_read_b64_tr_b16 a[148:149], v39 offset:61440
    ds_read_b64_tr_b16 a[150:151], v39 offset:61952
    buffer_load_dwordx4 v13, s[8:11], s78 offen offset:1024 lds
    v_rcp_f32 v236, v236
    v_rcp_f32 v237, v237
    v_rcp_f32 v238, v238
    v_rcp_f32 v239, v239
    v_fma_f32 v236, v236, v56, v55
    v_fma_f32 v237, v237, v56, v55
    v_fma_f32 v238, v238, v56, v55
    v_fma_f32 v239, v239, v56, v55
    s_waitcnt lgkmcnt(4)
    v_mfma_f32_32x32x16_bf16 v[112:127], a[140:143], a[20:23], v[112:127]
    ds_read_b64_tr_b16 a[152:153], v38 offset:63488
    ds_read_b64_tr_b16 a[154:155], v38 offset:64000
    v_mul_f32 v236, v68, v236
    v_mul_f32 v237, v69, v237
    v_mul_f32 v238, v70, v238
    v_mul_f32 v239, v71, v239
    v_cvt_pk_bf16_f32 v242, v236, v237
    v_cvt_pk_bf16_f32 v243, v238, v239
    v_mul_f32 v232, s51, v72
    v_mul_f32 v233, s51, v73
    v_mul_f32 v234, s51, v74
    v_mul_f32 v235, s51, v75
    v_exp_f32 v232, v232
    s_add_u32 m0, s58, 139264
    v_mfma_f32_32x32x16_bf16 v[96:111], a[136:139], a[20:23], v[96:111]
    ds_read_b64_tr_b16 a[156:157], v39 offset:63488
    ds_read_b64_tr_b16 a[158:159], v39 offset:64000
    buffer_load_dwordx4 v12, s[8:11], s79 offen lds
    v_exp_f32 v233, v233
    v_exp_f32 v234, v234
    v_exp_f32 v235, v235
    v_add_f32 v232, 1.0, v232
    v_add_f32 v233, 1.0, v233
    v_add_f32 v234, 1.0, v234
    v_add_f32 v235, 1.0, v235
    v_fma_f32 v232, v232, v232, 1.0
    v_fma_f32 v233, v233, v233, 1.0
    s_waitcnt lgkmcnt(4)
    v_mfma_f32_32x32x16_bf16 v[112:127], a[148:151], a[24:27], v[112:127]
    s_barrier
    ds_read_b64_tr_b16 a[128:129], v40 offset:0
    ds_read_b64_tr_b16 a[130:131], v40 offset:512
    v_fma_f32 v234, v234, v234, 1.0
    v_fma_f32 v235, v235, v235, 1.0
    v_rcp_f32 v232, v232
    v_rcp_f32 v233, v233
    v_rcp_f32 v234, v234
    v_rcp_f32 v235, v235
    v_fma_f32 v232, v232, v56, v55
    v_fma_f32 v233, v233, v56, v55
    v_mfma_f32_32x32x16_bf16 v[96:111], a[144:147], a[24:27], v[96:111]
    ds_read_b64_tr_b16 a[132:133], v41 offset:0
    ds_read_b64_tr_b16 a[134:135], v41 offset:512
    buffer_load_dwordx4 v13, s[8:11], s79 offen offset:1024 lds
    v_fma_f32 v234, v234, v56, v55
    v_fma_f32 v235, v235, v56, v55
    v_mul_f32 v232, v72, v232
    v_mul_f32 v233, v73, v233
    v_mul_f32 v234, v74, v234
    v_mul_f32 v235, v75, v235
    v_cvt_pk_bf16_f32 v244, v232, v233
    v_cvt_pk_bf16_f32 v245, v234, v235
    v_mul_f32 v236, s51, v76
    v_mul_f32 v237, s51, v77
    v_mul_f32 v238, s51, v78
    s_waitcnt lgkmcnt(4)
    v_mfma_f32_32x32x16_bf16 v[112:127], a[156:159], a[28:31], v[112:127]
    ds_read_b64_tr_b16 a[136:137], v40 offset:2048
    ds_read_b64_tr_b16 a[138:139], v40 offset:2560
    v_mul_f32 v239, s51, v79
    v_exp_f32 v236, v236
    v_exp_f32 v237, v237
    v_exp_f32 v238, v238
    v_exp_f32 v239, v239
    v_add_f32 v236, 1.0, v236
    v_add_f32 v237, 1.0, v237
    v_add_f32 v238, 1.0, v238
    s_add_u32 m0, s59, 32768
    v_mfma_f32_32x32x16_bf16 v[96:111], a[152:155], a[28:31], v[96:111]
    ds_read_b64_tr_b16 a[140:141], v41 offset:2048
    ds_read_b64_tr_b16 a[142:143], v41 offset:2560
    buffer_load_dwordx4 v18, s[16:19], s92 offen lds
    v_add_f32 v239, 1.0, v239
    v_fma_f32 v236, v236, v236, 1.0
    v_fma_f32 v237, v237, v237, 1.0
    v_fma_f32 v238, v238, v238, 1.0
    v_fma_f32 v239, v239, v239, 1.0
    v_rcp_f32 v236, v236
    v_rcp_f32 v237, v237
    v_rcp_f32 v238, v238
    s_waitcnt lgkmcnt(4)
    v_mfma_f32_32x32x16_bf16 v[112:127], a[132:135], a[32:35], v[112:127]
    ds_read_b64_tr_b16 a[144:145], v40 offset:4096
    ds_read_b64_tr_b16 a[146:147], v40 offset:4608
    v_rcp_f32 v239, v239
    v_fma_f32 v236, v236, v56, v55
    v_fma_f32 v237, v237, v56, v55
    v_fma_f32 v238, v238, v56, v55
    v_fma_f32 v239, v239, v56, v55
    v_mul_f32 v236, v76, v236
    v_mul_f32 v237, v77, v237
    v_mul_f32 v238, v78, v238
    v_mul_f32 v239, v79, v239
    v_cvt_pk_bf16_f32 v246, v236, v237
    v_cvt_pk_bf16_f32 v247, v238, v239
    v_mul_f32 v232, s51, v80
    v_mfma_f32_32x32x16_bf16 v[96:111], a[128:131], a[32:35], v[96:111]
    ds_read_b64_tr_b16 a[148:149], v41 offset:4096
    ds_read_b64_tr_b16 a[150:151], v41 offset:4608
    buffer_load_dwordx4 v19, s[16:19], s92 offen offset:1024 lds
    v_mul_f32 v233, s51, v81
    v_mul_f32 v234, s51, v82
    v_mul_f32 v235, s51, v83
    v_exp_f32 v232, v232
    v_exp_f32 v233, v233
    v_exp_f32 v234, v234
    v_exp_f32 v235, v235
    v_add_f32 v232, 1.0, v232
    s_waitcnt lgkmcnt(4)
    v_mfma_f32_32x32x16_bf16 v[112:127], a[140:143], a[36:39], v[112:127]
    ds_read_b64_tr_b16 a[152:153], v40 offset:6144
    ds_read_b64_tr_b16 a[154:155], v40 offset:6656
    v_add_f32 v233, 1.0, v233
    v_add_f32 v234, 1.0, v234
    v_add_f32 v235, 1.0, v235
    v_fma_f32 v232, v232, v232, 1.0
    v_fma_f32 v233, v233, v233, 1.0
    v_fma_f32 v234, v234, v234, 1.0
    v_fma_f32 v235, v235, v235, 1.0
    v_rcp_f32 v232, v232
    v_rcp_f32 v233, v233
    s_add_u32 m0, s59, 34816
    v_mfma_f32_32x32x16_bf16 v[96:111], a[136:139], a[36:39], v[96:111]
    ds_read_b64_tr_b16 a[156:157], v41 offset:6144
    ds_read_b64_tr_b16 a[158:159], v41 offset:6656
    buffer_load_dwordx4 v18, s[16:19], s93 offen lds
    v_rcp_f32 v234, v234
    v_rcp_f32 v235, v235
    v_fma_f32 v232, v232, v56, v55
    v_fma_f32 v233, v233, v56, v55
    v_fma_f32 v234, v234, v56, v55
    v_fma_f32 v235, v235, v56, v55
    v_mul_f32 v232, v80, v232
    v_mul_f32 v233, v81, v233
    v_mul_f32 v234, v82, v234
    v_mul_f32 v235, v83, v235
    s_waitcnt lgkmcnt(4)
    v_mfma_f32_32x32x16_bf16 v[112:127], a[148:151], a[40:43], v[112:127]
    ds_read_b64_tr_b16 a[128:129], v40 offset:8192
    ds_read_b64_tr_b16 a[130:131], v40 offset:8704
    v_cvt_pk_bf16_f32 v248, v232, v233
    v_cvt_pk_bf16_f32 v249, v234, v235
    v_mul_f32 v236, s51, v84
    v_mul_f32 v237, s51, v85
    v_mul_f32 v238, s51, v86
    v_mul_f32 v239, s51, v87
    v_exp_f32 v236, v236
    v_exp_f32 v237, v237
    v_exp_f32 v238, v238
    v_mfma_f32_32x32x16_bf16 v[96:111], a[144:147], a[40:43], v[96:111]
    ds_read_b64_tr_b16 a[132:133], v41 offset:8192
    ds_read_b64_tr_b16 a[134:135], v41 offset:8704
    buffer_load_dwordx4 v19, s[16:19], s93 offen offset:1024 lds
    v_exp_f32 v239, v239
    v_add_f32 v236, 1.0, v236
    v_add_f32 v237, 1.0, v237
    v_add_f32 v238, 1.0, v238
    v_add_f32 v239, 1.0, v239
    v_fma_f32 v236, v236, v236, 1.0
    v_fma_f32 v237, v237, v237, 1.0
    v_fma_f32 v238, v238, v238, 1.0
    v_fma_f32 v239, v239, v239, 1.0
    v_rcp_f32 v236, v236
    s_waitcnt lgkmcnt(4)
    v_mfma_f32_32x32x16_bf16 v[112:127], a[156:159], a[44:47], v[112:127]
    ds_read_b64_tr_b16 a[136:137], v40 offset:10240
    ds_read_b64_tr_b16 a[138:139], v40 offset:10752
    v_rcp_f32 v237, v237
    v_rcp_f32 v238, v238
    v_rcp_f32 v239, v239
    v_fma_f32 v236, v236, v56, v55
    v_fma_f32 v237, v237, v56, v55
    v_fma_f32 v238, v238, v56, v55
    v_fma_f32 v239, v239, v56, v55
    v_mul_f32 v236, v84, v236
    s_add_u32 m0, s58, 0
    v_mfma_f32_32x32x16_bf16 v[96:111], a[152:155], a[44:47], v[96:111]
    ds_read_b64_tr_b16 a[140:141], v41 offset:10240
    ds_read_b64_tr_b16 a[142:143], v41 offset:10752
    buffer_load_dwordx4 v12, s[8:11], s80 offen lds
    v_mul_f32 v237, v85, v237
    v_mul_f32 v238, v86, v238
    v_mul_f32 v239, v87, v239
    v_cvt_pk_bf16_f32 v250, v236, v237
    v_cvt_pk_bf16_f32 v251, v238, v239
    v_mul_f32 v232, s51, v88
    v_mul_f32 v233, s51, v89
    v_mul_f32 v234, s51, v90
    v_mul_f32 v235, s51, v91
    v_exp_f32 v232, v232
    v_exp_f32 v233, v233
    s_waitcnt lgkmcnt(4)
    v_mfma_f32_32x32x16_bf16 v[112:127], a[132:135], a[48:51], v[112:127]
    ds_read_b64_tr_b16 a[144:145], v40 offset:12288
    ds_read_b64_tr_b16 a[146:147], v40 offset:12800
    v_exp_f32 v234, v234
    v_exp_f32 v235, v235
    v_add_f32 v232, 1.0, v232
    v_add_f32 v233, 1.0, v233
    v_add_f32 v234, 1.0, v234
    v_add_f32 v235, 1.0, v235
    v_fma_f32 v232, v232, v232, 1.0
    v_fma_f32 v233, v233, v233, 1.0
    v_fma_f32 v234, v234, v234, 1.0
    v_mfma_f32_32x32x16_bf16 v[96:111], a[128:131], a[48:51], v[96:111]
    ds_read_b64_tr_b16 a[148:149], v41 offset:12288
    ds_read_b64_tr_b16 a[150:151], v41 offset:12800
    buffer_load_dwordx4 v13, s[8:11], s80 offen offset:1024 lds
    v_fma_f32 v235, v235, v235, 1.0
    v_rcp_f32 v232, v232
    v_rcp_f32 v233, v233
    v_rcp_f32 v234, v234
    v_rcp_f32 v235, v235
    v_fma_f32 v232, v232, v56, v55
    v_fma_f32 v233, v233, v56, v55
    v_fma_f32 v234, v234, v56, v55
    s_waitcnt lgkmcnt(4)
    v_mfma_f32_32x32x16_bf16 v[112:127], a[140:143], a[52:55], v[112:127]
    ds_read_b64_tr_b16 a[152:153], v40 offset:14336
    ds_read_b64_tr_b16 a[154:155], v40 offset:14848
    v_fma_f32 v235, v235, v56, v55
    v_mul_f32 v232, v88, v232
    v_mul_f32 v233, v89, v233
    v_mul_f32 v234, v90, v234
    v_mul_f32 v235, v91, v235
    v_cvt_pk_bf16_f32 v252, v232, v233
    v_cvt_pk_bf16_f32 v253, v234, v235
    v_mul_f32 v236, s51, v92
    v_mul_f32 v237, s51, v93
    v_mul_f32 v238, s51, v94
    v_mul_f32 v239, s51, v95
    s_add_u32 m0, s58, 8192
    v_mfma_f32_32x32x16_bf16 v[96:111], a[136:139], a[52:55], v[96:111]
    ds_read_b64_tr_b16 a[156:157], v41 offset:14336
    ds_read_b64_tr_b16 a[158:159], v41 offset:14848
    buffer_load_dwordx4 v12, s[8:11], s81 offen lds
    v_exp_f32 v236, v236
    v_exp_f32 v237, v237
    v_exp_f32 v238, v238
    v_exp_f32 v239, v239
    v_add_f32 v236, 1.0, v236
    v_add_f32 v237, 1.0, v237
    v_add_f32 v238, 1.0, v238
    v_add_f32 v239, 1.0, v239
    s_waitcnt lgkmcnt(4)
    v_mfma_f32_32x32x16_bf16 v[112:127], a[148:151], a[56:59], v[112:127]
    s_waitcnt vmcnt(19)
    s_barrier
    ds_read_b64_tr_b16 a[128:129], v40 offset:16384
    ds_read_b64_tr_b16 a[130:131], v40 offset:16896
    v_fma_f32 v236, v236, v236, 1.0
    v_fma_f32 v237, v237, v237, 1.0
    v_fma_f32 v238, v238, v238, 1.0
    v_fma_f32 v239, v239, v239, 1.0
    v_rcp_f32 v236, v236
    v_rcp_f32 v237, v237
    v_rcp_f32 v238, v238
    v_rcp_f32 v239, v239
    v_mfma_f32_32x32x16_bf16 v[96:111], a[144:147], a[56:59], v[96:111]
    ds_read_b64_tr_b16 a[132:133], v41 offset:16384
    ds_read_b64_tr_b16 a[134:135], v41 offset:16896
    buffer_load_dwordx4 v13, s[8:11], s81 offen offset:1024 lds
    v_fma_f32 v236, v236, v56, v55
    v_fma_f32 v237, v237, v56, v55
    v_fma_f32 v238, v238, v56, v55
    v_fma_f32 v239, v239, v56, v55
    v_mul_f32 v236, v92, v236
    v_mul_f32 v237, v93, v237
    v_mul_f32 v238, v94, v238
    v_mul_f32 v239, v95, v239
    v_cvt_pk_bf16_f32 v254, v236, v237
    v_cvt_pk_bf16_f32 v255, v238, v239
    v_or_b32 v15, 0x80000000, v54
    s_waitcnt lgkmcnt(4)
    v_mfma_f32_32x32x16_bf16 v[112:127], a[156:159], a[60:63], v[112:127]
    ds_read_b64_tr_b16 a[136:137], v40 offset:18432
    ds_read_b64_tr_b16 a[138:139], v40 offset:18944
    buffer_store_dwordx4 v[240:243], v4, s[24:27], 0 offen offset:0 sc1
    buffer_store_dwordx4 v[244:247], v4, s[24:27], 0 offen offset:1024 sc1
    buffer_store_dwordx4 v[248:251], v4, s[24:27], 0 offen offset:2048 sc1
    buffer_store_dwordx4 v[252:255], v4, s[24:27], 0 offen offset:3072 sc1
    buffer_store_dword v15, v14, s[24:27], 0 offen sc1
    s_add_u32 m0, s58, 16384
    v_mfma_f32_32x32x16_bf16 v[96:111], a[152:155], a[60:63], v[96:111]
    ds_read_b64_tr_b16 a[140:141], v41 offset:18432
    ds_read_b64_tr_b16 a[142:143], v41 offset:18944
    buffer_load_dwordx4 v12, s[8:11], s82 offen lds
    s_waitcnt lgkmcnt(4)
    v_mfma_f32_32x32x16_bf16 v[112:127], a[132:135], a[64:67], v[112:127]
    ds_read_b64_tr_b16 a[144:145], v40 offset:20480
    ds_read_b64_tr_b16 a[146:147], v40 offset:20992
    v_mfma_f32_32x32x16_bf16 v[96:111], a[128:131], a[64:67], v[96:111]
    ds_read_b64_tr_b16 a[148:149], v41 offset:20480
    ds_read_b64_tr_b16 a[150:151], v41 offset:20992
    buffer_load_dwordx4 v13, s[8:11], s82 offen offset:1024 lds
    s_waitcnt lgkmcnt(4)
    v_mfma_f32_32x32x16_bf16 v[112:127], a[140:143], a[68:71], v[112:127]
    ds_read_b64_tr_b16 a[152:153], v40 offset:22528
    ds_read_b64_tr_b16 a[154:155], v40 offset:23040
    s_waitcnt vmcnt(11)
    ds_read_b64_tr_b16 v[128:129], v44 offset:32768
    ds_read_b64_tr_b16 v[130:131], v44 offset:33792
    ds_read_b64_tr_b16 v[132:133], v45 offset:32768
    ds_read_b64_tr_b16 v[134:135], v45 offset:33792
    s_add_u32 m0, s58, 24576
    v_mfma_f32_32x32x16_bf16 v[96:111], a[136:139], a[68:71], v[96:111]
    ds_read_b64_tr_b16 a[156:157], v41 offset:22528
    ds_read_b64_tr_b16 a[158:159], v41 offset:23040
    ds_read_b64_tr_b16 v[136:137], v44 offset:34816
    ds_read_b64_tr_b16 v[138:139], v44 offset:35840
    ds_read_b64_tr_b16 v[140:141], v45 offset:34816
    ds_read_b64_tr_b16 v[142:143], v45 offset:35840
    buffer_load_dwordx4 v12, s[8:11], s83 offen lds
    s_waitcnt lgkmcnt(12)
    v_mfma_f32_32x32x16_bf16 v[112:127], a[148:151], a[72:75], v[112:127]
    ds_read_b64_tr_b16 a[128:129], v40 offset:24576
    ds_read_b64_tr_b16 a[130:131], v40 offset:25088
    v_mfma_f32_32x32x16_bf16 v[96:111], a[144:147], a[72:75], v[96:111]
    ds_read_b64_tr_b16 a[132:133], v41 offset:24576
    ds_read_b64_tr_b16 a[134:135], v41 offset:25088
    buffer_load_dwordx4 v13, s[8:11], s83 offen offset:1024 lds
    s_waitcnt lgkmcnt(8)
    v_mfma_f32_32x32x16_bf16 v[112:127], a[156:159], a[76:79], v[112:127]
    ds_read_b64_tr_b16 a[136:137], v40 offset:26624
    ds_read_b64_tr_b16 a[138:139], v40 offset:27136
    s_add_u32 m0, s59, 32768
    v_mfma_f32_32x32x16_bf16 v[96:111], a[152:155], a[76:79], v[96:111]
    ds_read_b64_tr_b16 a[140:141], v41 offset:26624
    ds_read_b64_tr_b16 a[142:143], v41 offset:27136
    s_waitcnt lgkmcnt(8)
    buffer_load_dwordx4 v18, s[16:19], s94 offen lds
    s_waitcnt lgkmcnt(4)
    v_mfma_f32_32x32x16_bf16 v[112:127], a[132:135], a[80:83], v[112:127]
    ds_read_b64_tr_b16 a[144:145], v40 offset:28672
    ds_read_b64_tr_b16 a[146:147], v40 offset:29184
    v_mfma_f32_32x32x16_bf16 v[96:111], a[128:131], a[80:83], v[96:111]
    ds_read_b64_tr_b16 a[148:149], v41 offset:28672
    ds_read_b64_tr_b16 a[150:151], v41 offset:29184
    buffer_load_dwordx4 v19, s[16:19], s94 offen offset:1024 lds
    s_waitcnt lgkmcnt(4)
    v_mfma_f32_32x32x16_bf16 v[112:127], a[140:143], a[84:87], v[112:127]
    ds_read_b64_tr_b16 a[152:153], v40 offset:30720
    ds_read_b64_tr_b16 a[154:155], v40 offset:31232
    s_add_u32 m0, s59, 34816
    v_mfma_f32_32x32x16_bf16 v[96:111], a[136:139], a[84:87], v[96:111]
    ds_read_b64_tr_b16 a[156:157], v41 offset:30720
    ds_read_b64_tr_b16 a[158:159], v41 offset:31232
    buffer_load_dwordx4 v18, s[16:19], s95 offen lds
    s_waitcnt lgkmcnt(4)
    v_mfma_f32_32x32x16_bf16 v[112:127], a[148:151], a[88:91], v[112:127]
    s_barrier
    ds_read_b64_tr_b16 a[128:129], v40 offset:32768
    ds_read_b64_tr_b16 a[130:131], v40 offset:33280
    v_mfma_f32_32x32x16_bf16 v[96:111], a[144:147], a[88:91], v[96:111]
    ds_read_b64_tr_b16 a[132:133], v41 offset:32768
    ds_read_b64_tr_b16 a[134:135], v41 offset:33280
    buffer_load_dwordx4 v19, s[16:19], s95 offen offset:1024 lds
    s_waitcnt lgkmcnt(4)
    v_mfma_f32_32x32x16_bf16 v[112:127], a[156:159], a[92:95], v[112:127]
    ds_read_b64_tr_b16 a[136:137], v40 offset:34816
    ds_read_b64_tr_b16 a[138:139], v40 offset:35328
    s_add_u32 m0, s59, 49152
    v_mfma_f32_32x32x16_bf16 v[96:111], a[152:155], a[92:95], v[96:111]
    ds_read_b64_tr_b16 a[140:141], v41 offset:34816
    ds_read_b64_tr_b16 a[142:143], v41 offset:35328
    buffer_load_dwordx4 v20, s[16:19], s92 offen lds
    s_waitcnt lgkmcnt(4)
    v_mfma_f32_32x32x16_bf16 v[112:127], a[132:135], a[96:99], v[112:127]
    ds_read_b64_tr_b16 a[144:145], v40 offset:36864
    ds_read_b64_tr_b16 a[146:147], v40 offset:37376
    v_mfma_f32_32x32x16_bf16 v[96:111], a[128:131], a[96:99], v[96:111]
    ds_read_b64_tr_b16 a[148:149], v41 offset:36864
    ds_read_b64_tr_b16 a[150:151], v41 offset:37376
    buffer_load_dwordx4 v21, s[16:19], s92 offen offset:1024 lds
    s_waitcnt lgkmcnt(4)
    v_mfma_f32_32x32x16_bf16 v[112:127], a[140:143], a[100:103], v[112:127]
    ds_read_b64_tr_b16 a[152:153], v40 offset:38912
    ds_read_b64_tr_b16 a[154:155], v40 offset:39424
    s_add_u32 m0, s59, 51200
    v_mfma_f32_32x32x16_bf16 v[96:111], a[136:139], a[100:103], v[96:111]
    ds_read_b64_tr_b16 a[156:157], v41 offset:38912
    ds_read_b64_tr_b16 a[158:159], v41 offset:39424
    buffer_load_dwordx4 v20, s[16:19], s93 offen lds
    s_waitcnt lgkmcnt(4)
    v_mfma_f32_32x32x16_bf16 v[112:127], a[148:151], a[104:107], v[112:127]
    ds_read_b64_tr_b16 a[128:129], v40 offset:40960
    ds_read_b64_tr_b16 a[130:131], v40 offset:41472
    v_mfma_f32_32x32x16_bf16 v[96:111], a[144:147], a[104:107], v[96:111]
    ds_read_b64_tr_b16 a[132:133], v41 offset:40960
    ds_read_b64_tr_b16 a[134:135], v41 offset:41472
    buffer_load_dwordx4 v21, s[16:19], s93 offen offset:1024 lds
    s_waitcnt lgkmcnt(4)
    v_mfma_f32_32x32x16_bf16 v[112:127], a[156:159], a[108:111], v[112:127]
    ds_read_b64_tr_b16 a[136:137], v40 offset:43008
    ds_read_b64_tr_b16 a[138:139], v40 offset:43520
    s_add_u32 m0, s59, 65536
    v_mfma_f32_32x32x16_bf16 v[96:111], a[152:155], a[108:111], v[96:111]
    ds_read_b64_tr_b16 a[140:141], v41 offset:43008
    ds_read_b64_tr_b16 a[142:143], v41 offset:43520
    buffer_load_dwordx4 v22, s[16:19], s92 offen lds
    s_waitcnt lgkmcnt(4)
    v_mfma_f32_32x32x16_bf16 v[112:127], a[132:135], a[112:115], v[112:127]
    ds_read_b64_tr_b16 a[144:145], v40 offset:45056
    ds_read_b64_tr_b16 a[146:147], v40 offset:45568
    v_mfma_f32_32x32x16_bf16 v[96:111], a[128:131], a[112:115], v[96:111]
    ds_read_b64_tr_b16 a[148:149], v41 offset:45056
    ds_read_b64_tr_b16 a[150:151], v41 offset:45568
    buffer_load_dwordx4 v23, s[16:19], s92 offen offset:1024 lds
    s_waitcnt lgkmcnt(4)
    v_mfma_f32_32x32x16_bf16 v[112:127], a[140:143], a[116:119], v[112:127]
    ds_read_b64_tr_b16 a[152:153], v40 offset:47104
    ds_read_b64_tr_b16 a[154:155], v40 offset:47616
    s_add_u32 m0, s59, 67584
    v_mfma_f32_32x32x16_bf16 v[96:111], a[136:139], a[116:119], v[96:111]
    ds_read_b64_tr_b16 a[156:157], v41 offset:47104
    ds_read_b64_tr_b16 a[158:159], v41 offset:47616
    buffer_load_dwordx4 v22, s[16:19], s93 offen lds
    s_waitcnt lgkmcnt(4)
    v_mfma_f32_32x32x16_bf16 v[112:127], a[148:151], a[120:123], v[112:127]
    s_barrier
    ds_read_b64_tr_b16 a[128:129], v40 offset:49152
    ds_read_b64_tr_b16 a[130:131], v40 offset:49664
    s_waitcnt vmcnt(7)
    ds_read_b64_tr_b16 v[144:145], v44 offset:32768
    ds_read_b64_tr_b16 v[146:147], v44 offset:33792
    ds_read_b64_tr_b16 v[148:149], v45 offset:32768
    ds_read_b64_tr_b16 v[150:151], v45 offset:33792
    v_mfma_f32_32x32x16_bf16 v[112:127], a[182:185], a[186:189], v[112:127]
    ds_read_b64_tr_b16 a[132:133], v41 offset:49152
    ds_read_b64_tr_b16 a[134:135], v41 offset:49664
    ds_read_b64_tr_b16 v[152:153], v44 offset:34816
    ds_read_b64_tr_b16 v[154:155], v44 offset:35840
    ds_read_b64_tr_b16 v[156:157], v45 offset:34816
    ds_read_b64_tr_b16 v[158:159], v45 offset:35840
    buffer_load_dwordx4 v23, s[16:19], s93 offen offset:1024 lds
    v_mov_b32 v61, 1
    v_mfma_f32_32x32x16_bf16 v[96:111], a[144:147], a[120:123], v[96:111]
    s_mov_b64 exec, 1
    buffer_atomic_add v61, off, s[24:27], s36 offset:0 sc1
    s_mov_b64 exec, -1
    s_add_u32 m0, s59, 81920
    s_lshl_b32 s54, s84, 4
    v_mfma_f32_32x32x16_bf16 v[96:111], a[180:183], a[186:189], v[96:111]
    buffer_load_dwordx4 v26, s[20:23], s54 offen lds
    s_waitcnt lgkmcnt(12)
    v_mfma_f32_32x32x16_bf16 v[112:127], a[156:159], a[124:127], v[112:127]
    ds_read_b64_tr_b16 a[136:137], v40 offset:51200
    ds_read_b64_tr_b16 a[138:139], v40 offset:51712
    v_mfma_f32_32x32x16_bf16 v[96:111], a[152:155], a[124:127], v[96:111]
    ds_read_b64_tr_b16 a[140:141], v41 offset:51200
    ds_read_b64_tr_b16 a[142:143], v41 offset:51712
    buffer_load_dwordx4 v27, s[20:23], s54 offen offset:1024 lds
    s_waitcnt lgkmcnt(8)
    v_mfma_f32_32x32x16_bf16 v[80:95], a[132:135], a[0:3], 0
    ds_read_b64_tr_b16 a[144:145], v40 offset:53248
    ds_read_b64_tr_b16 a[146:147], v40 offset:53760
    s_add_u32 m0, s59, 83968
    s_lshl_b32 s54, s85, 4
    v_mfma_f32_32x32x16_bf16 v[64:79], a[128:131], a[0:3], 0
    ds_read_b64_tr_b16 a[148:149], v41 offset:53248
    ds_read_b64_tr_b16 a[150:151], v41 offset:53760
    buffer_load_dwordx4 v26, s[20:23], s54 offen lds
    s_waitcnt lgkmcnt(4)
    v_mfma_f32_32x32x16_bf16 v[80:95], a[140:143], a[4:7], v[80:95]
    ds_read_b64_tr_b16 a[152:153], v40 offset:55296
    ds_read_b64_tr_b16 a[154:155], v40 offset:55808
    v_mfma_f32_32x32x16_bf16 v[64:79], a[136:139], a[4:7], v[64:79]
    ds_read_b64_tr_b16 a[156:157], v41 offset:55296
    ds_read_b64_tr_b16 a[158:159], v41 offset:55808
    buffer_load_dwordx4 v27, s[20:23], s54 offen offset:1024 lds
    v_mul_f32 v232, s51, v96
    v_mul_f32 v233, s51, v97
    v_mul_f32 v234, s51, v98
    v_mul_f32 v235, s51, v99
    v_exp_f32 v232, v232
    v_exp_f32 v233, v233
    s_waitcnt lgkmcnt(4)
    v_mfma_f32_32x32x16_bf16 v[80:95], a[148:151], a[8:11], v[80:95]
    ds_read_b64_tr_b16 a[128:129], v40 offset:57344
    ds_read_b64_tr_b16 a[130:131], v40 offset:57856
    v_exp_f32 v234, v234
    v_exp_f32 v235, v235
    v_add_f32 v232, 1.0, v232
    v_add_f32 v233, 1.0, v233
    v_add_f32 v234, 1.0, v234
    s_add_u32 m0, s59, 32768
    v_mfma_f32_32x32x16_bf16 v[64:79], a[144:147], a[8:11], v[64:79]
    ds_read_b64_tr_b16 a[132:133], v41 offset:57344
    ds_read_b64_tr_b16 a[134:135], v41 offset:57856
    buffer_load_dwordx4 v18, s[16:19], s96 offen lds
    v_add_f32 v235, 1.0, v235
    v_fma_f32 v232, v232, v232, 1.0
    v_fma_f32 v233, v233, v233, 1.0
    v_fma_f32 v234, v234, v234, 1.0
    v_fma_f32 v235, v235, v235, 1.0
    v_rcp_f32 v232, v232
    s_waitcnt lgkmcnt(4)
    v_mfma_f32_32x32x16_bf16 v[80:95], a[156:159], a[12:15], v[80:95]
    ds_read_b64_tr_b16 a[136:137], v40 offset:59392
    ds_read_b64_tr_b16 a[138:139], v40 offset:59904
    v_rcp_f32 v233, v233
    v_rcp_f32 v234, v234
    v_rcp_f32 v235, v235
    v_fma_f32 v232, v232, v56, v55
    v_fma_f32 v233, v233, v56, v55
    v_fma_f32 v234, v234, v56, v55
    v_mfma_f32_32x32x16_bf16 v[64:79], a[152:155], a[12:15], v[64:79]
    ds_read_b64_tr_b16 a[140:141], v41 offset:59392
    ds_read_b64_tr_b16 a[142:143], v41 offset:59904
    buffer_load_dwordx4 v19, s[16:19], s96 offen offset:1024 lds
    v_fma_f32 v235, v235, v56, v55
    v_mul_f32 v232, v96, v232
    v_mul_f32 v233, v97, v233
    v_mul_f32 v234, v98, v234
    v_mul_f32 v235, v99, v235
    v_cvt_pk_bf16_f32 v208, v232, v233
    v_cvt_pk_bf16_f32 v209, v234, v235
    s_waitcnt lgkmcnt(4)
    v_mfma_f32_32x32x16_bf16 v[80:95], a[132:135], a[16:19], v[80:95]
    ds_read_b64_tr_b16 a[144:145], v40 offset:61440
    ds_read_b64_tr_b16 a[146:147], v40 offset:61952
    v_mul_f32 v236, s51, v100
    v_mul_f32 v237, s51, v101
    v_mul_f32 v238, s51, v102
    v_mul_f32 v239, s51, v103
    v_exp_f32 v236, v236
    v_exp_f32 v237, v237
    s_add_u32 m0, s59, 34816
    v_mfma_f32_32x32x16_bf16 v[64:79], a[128:131], a[16:19], v[64:79]
    ds_read_b64_tr_b16 a[148:149], v41 offset:61440
    ds_read_b64_tr_b16 a[150:151], v41 offset:61952
    buffer_load_dwordx4 v18, s[16:19], s97 offen lds
    v_exp_f32 v238, v238
    v_exp_f32 v239, v239
    v_add_f32 v236, 1.0, v236
    v_add_f32 v237, 1.0, v237
    v_add_f32 v238, 1.0, v238
    v_add_f32 v239, 1.0, v239
    s_waitcnt lgkmcnt(4)
    v_mfma_f32_32x32x16_bf16 v[80:95], a[140:143], a[20:23], v[80:95]
    ds_read_b64_tr_b16 a[152:153], v40 offset:63488
    ds_read_b64_tr_b16 a[154:155], v40 offset:64000
    v_fma_f32 v236, v236, v236, 1.0
    v_fma_f32 v237, v237, v237, 1.0
    v_fma_f32 v238, v238, v238, 1.0
    v_fma_f32 v239, v239, v239, 1.0
    v_rcp_f32 v236, v236
    v_rcp_f32 v237, v237
    v_mfma_f32_32x32x16_bf16 v[64:79], a[136:139], a[20:23], v[64:79]
    ds_read_b64_tr_b16 a[156:157], v41 offset:63488
    ds_read_b64_tr_b16 a[158:159], v41 offset:64000
    buffer_load_dwordx4 v19, s[16:19], s97 offen offset:1024 lds
    v_rcp_f32 v238, v238
    v_rcp_f32 v239, v239
    v_fma_f32 v236, v236, v56, v55
    v_fma_f32 v237, v237, v56, v55
    v_fma_f32 v238, v238, v56, v55
    s_waitcnt lgkmcnt(4)
    v_mfma_f32_32x32x16_bf16 v[80:95], a[148:151], a[24:27], v[80:95]
    s_barrier
    ds_read_b64_tr_b16 a[128:129], v42 offset:0
    ds_read_b64_tr_b16 a[130:131], v42 offset:512
    v_fma_f32 v239, v239, v56, v55
    v_mul_f32 v236, v100, v236
    v_mul_f32 v237, v101, v237
    v_mul_f32 v238, v102, v238
    v_mul_f32 v239, v103, v239
    v_cvt_pk_bf16_f32 v210, v236, v237
    v_cvt_pk_bf16_f32 v211, v238, v239
    v_mul_f32 v232, s51, v104
    s_add_u32 m0, s59, 98304
    s_and_b32 s54, s92, 0xc000
    v_mfma_f32_32x32x16_bf16 v[64:79], a[144:147], a[24:27], v[64:79]
    ds_read_b64_tr_b16 a[132:133], v43 offset:0
    ds_read_b64_tr_b16 a[134:135], v43 offset:512
    buffer_load_dwordx4 v24, s[16:19], s54 offen lds
    v_mul_f32 v233, s51, v105
    v_mul_f32 v234, s51, v106
    v_mul_f32 v235, s51, v107
    v_exp_f32 v232, v232
    v_exp_f32 v233, v233
    s_waitcnt lgkmcnt(4)
    v_mfma_f32_32x32x16_bf16 v[80:95], a[156:159], a[28:31], v[80:95]
    ds_read_b64_tr_b16 a[136:137], v42 offset:2048
    ds_read_b64_tr_b16 a[138:139], v42 offset:2560
    v_exp_f32 v234, v234
    v_exp_f32 v235, v235
    v_add_f32 v232, 1.0, v232
    v_add_f32 v233, 1.0, v233
    v_add_f32 v234, 1.0, v234
    v_add_f32 v235, 1.0, v235
    v_mfma_f32_32x32x16_bf16 v[64:79], a[152:155], a[28:31], v[64:79]
    ds_read_b64_tr_b16 a[140:141], v43 offset:2048
    ds_read_b64_tr_b16 a[142:143], v43 offset:2560
    buffer_load_dwordx4 v25, s[16:19], s54 offen offset:1024 lds
    v_fma_f32 v232, v232, v232, 1.0
    v_fma_f32 v233, v233, v233, 1.0
    v_fma_f32 v234, v234, v234, 1.0
    v_fma_f32 v235, v235, v235, 1.0
    v_rcp_f32 v232, v232
    v_rcp_f32 v233, v233
    s_waitcnt lgkmcnt(4)
    v_mfma_f32_32x32x16_bf16 v[80:95], a[132:135], a[32:35], v[80:95]
    ds_read_b64_tr_b16 a[144:145], v42 offset:4096
    ds_read_b64_tr_b16 a[146:147], v42 offset:4608
    v_rcp_f32 v234, v234
    v_rcp_f32 v235, v235
    v_fma_f32 v232, v232, v56, v55
    v_fma_f32 v233, v233, v56, v55
    v_fma_f32 v234, v234, v56, v55
    s_add_u32 m0, s59, 100352
    s_and_b32 s54, s93, 0xc000
    v_mfma_f32_32x32x16_bf16 v[64:79], a[128:131], a[32:35], v[64:79]
    ds_read_b64_tr_b16 a[148:149], v43 offset:4096
    ds_read_b64_tr_b16 a[150:151], v43 offset:4608
    buffer_load_dwordx4 v24, s[16:19], s54 offen lds
    v_fma_f32 v235, v235, v56, v55
    v_mul_f32 v232, v104, v232
    v_mul_f32 v233, v105, v233
    v_mul_f32 v234, v106, v234
    v_mul_f32 v235, v107, v235
    v_cvt_pk_bf16_f32 v212, v232, v233
    v_cvt_pk_bf16_f32 v213, v234, v235
    v_mul_f32 v236, s51, v108
    s_waitcnt lgkmcnt(4)
    v_mfma_f32_32x32x16_bf16 v[80:95], a[140:143], a[36:39], v[80:95]
    ds_read_b64_tr_b16 a[152:153], v42 offset:6144
    ds_read_b64_tr_b16 a[154:155], v42 offset:6656
    v_mul_f32 v237, s51, v109
    v_mul_f32 v238, s51, v110
    v_mul_f32 v239, s51, v111
    v_exp_f32 v236, v236
    v_exp_f32 v237, v237
    v_mfma_f32_32x32x16_bf16 v[64:79], a[136:139], a[36:39], v[64:79]
    ds_read_b64_tr_b16 a[156:157], v43 offset:6144
    ds_read_b64_tr_b16 a[158:159], v43 offset:6656
    buffer_load_dwordx4 v25, s[16:19], s54 offen offset:1024 lds
    v_exp_f32 v238, v238
    v_exp_f32 v239, v239
    v_add_f32 v236, 1.0, v236
    v_add_f32 v237, 1.0, v237
    v_add_f32 v238, 1.0, v238
    v_add_f32 v239, 1.0, v239
    s_waitcnt lgkmcnt(4)
    v_mfma_f32_32x32x16_bf16 v[80:95], a[148:151], a[40:43], v[80:95]
    ds_read_b64_tr_b16 a[128:129], v42 offset:8192
    ds_read_b64_tr_b16 a[130:131], v42 offset:8704
    v_fma_f32 v236, v236, v236, 1.0
    v_fma_f32 v237, v237, v237, 1.0
    v_fma_f32 v238, v238, v238, 1.0
    v_fma_f32 v239, v239, v239, 1.0
    v_rcp_f32 v236, v236
    v_rcp_f32 v237, v237
    v_mfma_f32_32x32x16_bf16 v[64:79], a[144:147], a[40:43], v[64:79]
    ds_read_b64_tr_b16 a[132:133], v43 offset:8192
    ds_read_b64_tr_b16 a[134:135], v43 offset:8704
    v_rcp_f32 v238, v238
    v_rcp_f32 v239, v239
    v_fma_f32 v236, v236, v56, v55
    v_fma_f32 v237, v237, v56, v55
    v_fma_f32 v238, v238, v56, v55
    v_fma_f32 v239, v239, v56, v55
    s_waitcnt lgkmcnt(4)
    v_mfma_f32_32x32x16_bf16 v[80:95], a[156:159], a[44:47], v[80:95]
    ds_read_b64_tr_b16 a[136:137], v42 offset:10240
    ds_read_b64_tr_b16 a[138:139], v42 offset:10752
    s_waitcnt vmcnt(4)
    ds_read_b64_tr_b16 v[160:161], v44 offset:32768
    ds_read_b64_tr_b16 v[162:163], v44 offset:33792
    ds_read_b64_tr_b16 v[164:165], v45 offset:32768
    ds_read_b64_tr_b16 v[166:167], v45 offset:33792
    v_mul_f32 v236, v108, v236
    v_mul_f32 v237, v109, v237
    v_mul_f32 v238, v110, v238
    v_mul_f32 v239, v111, v239
    v_cvt_pk_bf16_f32 v214, v236, v237
    v_cvt_pk_bf16_f32 v215, v238, v239
    v_mul_f32 v232, s51, v112
    v_mfma_f32_32x32x16_bf16 v[64:79], a[152:155], a[44:47], v[64:79]
    ds_read_b64_tr_b16 a[140:141], v43 offset:10240
    ds_read_b64_tr_b16 a[142:143], v43 offset:10752
    ds_read_b64_tr_b16 v[168:169], v44 offset:34816
    ds_read_b64_tr_b16 v[170:171], v44 offset:35840
    ds_read_b64_tr_b16 v[172:173], v45 offset:34816
    ds_read_b64_tr_b16 v[174:175], v45 offset:35840
    v_mul_f32 v233, s51, v113
    v_mul_f32 v234, s51, v114
    v_mul_f32 v235, s51, v115
    v_exp_f32 v232, v232
    v_exp_f32 v233, v233
    s_waitcnt lgkmcnt(12)
    v_mfma_f32_32x32x16_bf16 v[80:95], a[132:135], a[48:51], v[80:95]
    ds_read_b64_tr_b16 a[144:145], v42 offset:12288
    ds_read_b64_tr_b16 a[146:147], v42 offset:12800
    v_exp_f32 v234, v234
    v_exp_f32 v235, v235
    v_add_f32 v232, 1.0, v232
    v_add_f32 v233, 1.0, v233
    v_add_f32 v234, 1.0, v234
    v_add_f32 v235, 1.0, v235
    v_mfma_f32_32x32x16_bf16 v[64:79], a[128:131], a[48:51], v[64:79]
    ds_read_b64_tr_b16 a[148:149], v43 offset:12288
    ds_read_b64_tr_b16 a[150:151], v43 offset:12800
    v_fma_f32 v232, v232, v232, 1.0
    v_fma_f32 v233, v233, v233, 1.0
    v_fma_f32 v234, v234, v234, 1.0
    v_fma_f32 v235, v235, v235, 1.0
    v_rcp_f32 v232, v232
    v_rcp_f32 v233, v233
    s_waitcnt lgkmcnt(8)
    v_mfma_f32_32x32x16_bf16 v[80:95], a[140:143], a[52:55], v[80:95]
    ds_read_b64_tr_b16 a[152:153], v42 offset:14336
    ds_read_b64_tr_b16 a[154:155], v42 offset:14848
    v_rcp_f32 v234, v234
    v_rcp_f32 v235, v235
    v_fma_f32 v232, v232, v56, v55
    v_fma_f32 v233, v233, v56, v55
    v_fma_f32 v234, v234, v56, v55
    v_fma_f32 v235, v235, v56, v55
    s_add_u32 m0, s59, 32768
    v_mfma_f32_32x32x16_bf16 v[64:79], a[136:139], a[52:55], v[64:79]
    ds_read_b64_tr_b16 a[156:157], v43 offset:14336
    ds_read_b64_tr_b16 a[158:159], v43 offset:14848
    s_waitcnt lgkmcnt(8)
    buffer_load_dwordx4 v18, s[16:19], s98 offen lds
    v_mul_f32 v232, v112, v232
    v_mul_f32 v233, v113, v233
    v_mul_f32 v234, v114, v234
    v_mul_f32 v235, v115, v235
    v_cvt_pk_bf16_f32 v216, v232, v233
    v_cvt_pk_bf16_f32 v217, v234, v235
    v_mul_f32 v236, s51, v116
    s_waitcnt lgkmcnt(4)
    v_mfma_f32_32x32x16_bf16 v[80:95], a[148:151], a[56:59], v[80:95]
    s_barrier
    ds_read_b64_tr_b16 a[128:129], v38 offset:0
    ds_read_b64_tr_b16 a[130:131], v38 offset:512
    v_mul_f32 v237, s51, v117
    v_mul_f32 v238, s51, v118
    v_mul_f32 v239, s51, v119
    v_exp_f32 v236, v236
    v_exp_f32 v237, v237
    v_exp_f32 v238, v238
    v_mfma_f32_32x32x16_bf16 v[64:79], a[144:147], a[56:59], v[64:79]
    ds_read_b64_tr_b16 a[132:133], v39 offset:0
    ds_read_b64_tr_b16 a[134:135], v39 offset:512
    buffer_load_dwordx4 v19, s[16:19], s98 offen offset:1024 lds
    v_exp_f32 v239, v239
    v_add_f32 v236, 1.0, v236
    v_add_f32 v237, 1.0, v237
    v_add_f32 v238, 1.0, v238
    v_add_f32 v239, 1.0, v239
    v_fma_f32 v236, v236, v236, 1.0
    s_waitcnt lgkmcnt(4)
    v_mfma_f32_32x32x16_bf16 v[80:95], a[156:159], a[60:63], v[80:95]
    ds_read_b64_tr_b16 a[136:137], v38 offset:2048
    ds_read_b64_tr_b16 a[138:139], v38 offset:2560
    v_fma_f32 v237, v237, v237, 1.0
    v_fma_f32 v238, v238, v238, 1.0
    v_fma_f32 v239, v239, v239, 1.0
    v_rcp_f32 v236, v236
    v_rcp_f32 v237, v237
    s_add_u32 m0, s59, 34816
    v_mfma_f32_32x32x16_bf16 v[64:79], a[152:155], a[60:63], v[64:79]
    ds_read_b64_tr_b16 a[140:141], v39 offset:2048
    ds_read_b64_tr_b16 a[142:143], v39 offset:2560
    buffer_load_dwordx4 v18, s[16:19], s99 offen lds
    v_rcp_f32 v238, v238
    v_rcp_f32 v239, v239
    v_fma_f32 v236, v236, v56, v55
    v_fma_f32 v237, v237, v56, v55
    v_fma_f32 v238, v238, v56, v55
    v_fma_f32 v239, v239, v56, v55
    s_waitcnt lgkmcnt(4)
    v_mfma_f32_32x32x16_bf16 v[80:95], a[132:135], a[64:67], v[80:95]
    ds_read_b64_tr_b16 a[144:145], v38 offset:4096
    ds_read_b64_tr_b16 a[146:147], v38 offset:4608
    v_mul_f32 v236, v116, v236
    v_mul_f32 v237, v117, v237
    v_mul_f32 v238, v118, v238
    v_mul_f32 v239, v119, v239
    v_cvt_pk_bf16_f32 v218, v236, v237
    v_cvt_pk_bf16_f32 v219, v238, v239
    v_mul_f32 v232, s51, v120
    v_mul_f32 v233, s51, v121
    v_mfma_f32_32x32x16_bf16 v[64:79], a[128:131], a[64:67], v[64:79]
    ds_read_b64_tr_b16 a[148:149], v39 offset:4096
    ds_read_b64_tr_b16 a[150:151], v39 offset:4608
    buffer_load_dwordx4 v19, s[16:19], s99 offen offset:1024 lds
    v_mul_f32 v234, s51, v122
    v_mul_f32 v235, s51, v123
    v_exp_f32 v232, v232
    v_exp_f32 v233, v233
    v_exp_f32 v234, v234
    s_waitcnt lgkmcnt(4)
    v_mfma_f32_32x32x16_bf16 v[80:95], a[140:143], a[68:71], v[80:95]
    ds_read_b64_tr_b16 a[152:153], v38 offset:6144
    ds_read_b64_tr_b16 a[154:155], v38 offset:6656
    v_exp_f32 v235, v235
    v_add_f32 v232, 1.0, v232
    v_add_f32 v233, 1.0, v233
    v_add_f32 v234, 1.0, v234
    v_add_f32 v235, 1.0, v235
    v_fma_f32 v232, v232, v232, 1.0
    s_add_u32 m0, s59, 114688
    v_mfma_f32_32x32x16_bf16 v[64:79], a[136:139], a[68:71], v[64:79]
    ds_read_b64_tr_b16 a[156:157], v39 offset:6144
    ds_read_b64_tr_b16 a[158:159], v39 offset:6656
    buffer_load_dwordx4 v20, s[16:19], s94 offen lds
    v_fma_f32 v233, v233, v233, 1.0
    v_fma_f32 v234, v234, v234, 1.0
    v_fma_f32 v235, v235, v235, 1.0
    v_rcp_f32 v232, v232
    v_rcp_f32 v233, v233
    s_waitcnt lgkmcnt(4)
    v_mfma_f32_32x32x16_bf16 v[80:95], a[148:151], a[72:75], v[80:95]
    ds_read_b64_tr_b16 a[128:129], v38 offset:8192
    ds_read_b64_tr_b16 a[130:131], v38 offset:8704
    v_rcp_f32 v234, v234
    v_rcp_f32 v235, v235
    v_fma_f32 v232, v232, v56, v55
    v_fma_f32 v233, v233, v56, v55
    v_fma_f32 v234, v234, v56, v55
    v_fma_f32 v235, v235, v56, v55
    v_mfma_f32_32x32x16_bf16 v[64:79], a[144:147], a[72:75], v[64:79]
    ds_read_b64_tr_b16 a[132:133], v39 offset:8192
    ds_read_b64_tr_b16 a[134:135], v39 offset:8704
    buffer_load_dwordx4 v21, s[16:19], s94 offen offset:1024 lds
    v_mul_f32 v232, v120, v232
    v_mul_f32 v233, v121, v233
    v_mul_f32 v234, v122, v234
    v_mul_f32 v235, v123, v235
    v_cvt_pk_bf16_f32 v220, v232, v233
    v_cvt_pk_bf16_f32 v221, v234, v235
    v_mul_f32 v236, s51, v124
    v_mul_f32 v237, s51, v125
    s_waitcnt lgkmcnt(4)
    v_mfma_f32_32x32x16_bf16 v[80:95], a[156:159], a[76:79], v[80:95]
    ds_read_b64_tr_b16 a[136:137], v38 offset:10240
    ds_read_b64_tr_b16 a[138:139], v38 offset:10752
    v_mul_f32 v238, s51, v126
    v_mul_f32 v239, s51, v127
    v_exp_f32 v236, v236
    v_exp_f32 v237, v237
    v_exp_f32 v238, v238
    s_add_u32 m0, s59, 116736
    v_mfma_f32_32x32x16_bf16 v[64:79], a[152:155], a[76:79], v[64:79]
    ds_read_b64_tr_b16 a[140:141], v39 offset:10240
    ds_read_b64_tr_b16 a[142:143], v39 offset:10752
    buffer_load_dwordx4 v20, s[16:19], s95 offen lds
    v_exp_f32 v239, v239
    v_add_f32 v236, 1.0, v236
    v_add_f32 v237, 1.0, v237
    v_add_f32 v238, 1.0, v238
    v_add_f32 v239, 1.0, v239
    v_fma_f32 v236, v236, v236, 1.0
    s_waitcnt lgkmcnt(4)
    v_mfma_f32_32x32x16_bf16 v[80:95], a[132:135], a[80:83], v[80:95]
    ds_read_b64_tr_b16 a[144:145], v38 offset:12288
    ds_read_b64_tr_b16 a[146:147], v38 offset:12800
    v_fma_f32 v237, v237, v237, 1.0
    v_fma_f32 v238, v238, v238, 1.0
    v_fma_f32 v239, v239, v239, 1.0
    v_rcp_f32 v236, v236
    v_rcp_f32 v237, v237
    v_rcp_f32 v238, v238
    v_mfma_f32_32x32x16_bf16 v[64:79], a[128:131], a[80:83], v[64:79]
    ds_read_b64_tr_b16 a[148:149], v39 offset:12288
    ds_read_b64_tr_b16 a[150:151], v39 offset:12800
    buffer_load_dwordx4 v21, s[16:19], s95 offen offset:1024 lds
    v_rcp_f32 v239, v239
    v_fma_f32 v236, v236, v56, v55
    v_fma_f32 v237, v237, v56, v55
    v_fma_f32 v238, v238, v56, v55
    v_fma_f32 v239, v239, v56, v55
    v_mul_f32 v236, v124, v236
    s_waitcnt lgkmcnt(4)
    v_mfma_f32_32x32x16_bf16 v[80:95], a[140:143], a[84:87], v[80:95]
    ds_read_b64_tr_b16 a[152:153], v38 offset:14336
    ds_read_b64_tr_b16 a[154:155], v38 offset:14848
    v_mul_f32 v237, v125, v237
    v_mul_f32 v238, v126, v238
    v_mul_f32 v239, v127, v239
    v_cvt_pk_bf16_f32 v222, v236, v237
    v_cvt_pk_bf16_f32 v223, v238, v239
    v_mfma_f32_32x32x16_bf16 v[64:79], a[136:139], a[84:87], v[64:79]
    ds_read_b64_tr_b16 a[156:157], v39 offset:14336
    ds_read_b64_tr_b16 a[158:159], v39 offset:14848
    buffer_store_dwordx4 v[208:211], v5, s[24:27], 0 offen offset:0 sc1
    buffer_store_dwordx4 v[212:215], v5, s[24:27], 0 offen offset:1024 sc1
    buffer_store_dwordx4 v[216:219], v5, s[24:27], 0 offen offset:2048 sc1
    buffer_store_dwordx4 v[220:223], v5, s[24:27], 0 offen offset:3072 sc1
    s_waitcnt lgkmcnt(4)
    v_mfma_f32_32x32x16_bf16 v[80:95], a[148:151], a[88:91], v[80:95]
    s_barrier
    ds_read_b64_tr_b16 a[128:129], v38 offset:16384
    ds_read_b64_tr_b16 a[130:131], v38 offset:16896
    s_add_u32 m0, s59, 131072
    v_mfma_f32_32x32x16_bf16 v[64:79], a[144:147], a[88:91], v[64:79]
    ds_read_b64_tr_b16 a[132:133], v39 offset:16384
    ds_read_b64_tr_b16 a[134:135], v39 offset:16896
    buffer_load_dwordx4 v20, s[16:19], s96 offen lds
    s_waitcnt lgkmcnt(4)
    v_mfma_f32_32x32x16_bf16 v[80:95], a[156:159], a[92:95], v[80:95]
    ds_read_b64_tr_b16 a[136:137], v38 offset:18432
    ds_read_b64_tr_b16 a[138:139], v38 offset:18944
    s_load_dword s39, s[24:25], s38 offset:0 glc
    v_mfma_f32_32x32x16_bf16 v[64:79], a[152:155], a[92:95], v[64:79]
    ds_read_b64_tr_b16 a[140:141], v39 offset:18432
    ds_read_b64_tr_b16 a[142:143], v39 offset:18944
    buffer_load_dwordx4 v21, s[16:19], s96 offen offset:1024 lds
    s_waitcnt lgkmcnt(4)
    v_mfma_f32_32x32x16_bf16 v[80:95], a[132:135], a[96:99], v[80:95]
    ds_read_b64_tr_b16 a[144:145], v38 offset:20480
    ds_read_b64_tr_b16 a[146:147], v38 offset:20992
    s_waitcnt vmcnt(10)
    ds_read_b64_tr_b16 v[176:177], v44 offset:32768
    ds_read_b64_tr_b16 v[178:179], v44 offset:33792
    ds_read_b64_tr_b16 v[180:181], v45 offset:32768
    ds_read_b64_tr_b16 v[182:183], v45 offset:33792
    s_add_u32 m0, s59, 133120
    v_mfma_f32_32x32x16_bf16 v[64:79], a[128:131], a[96:99], v[64:79]
    ds_read_b64_tr_b16 a[148:149], v39 offset:20480
    ds_read_b64_tr_b16 a[150:151], v39 offset:20992
    ds_read_b64_tr_b16 v[184:185], v44 offset:34816
    ds_read_b64_tr_b16 v[186:187], v44 offset:35840
    ds_read_b64_tr_b16 v[188:189], v45 offset:34816
    ds_read_b64_tr_b16 v[190:191], v45 offset:35840
    buffer_load_dwordx4 v20, s[16:19], s97 offen lds
    s_waitcnt lgkmcnt(12)
    v_mfma_f32_32x32x16_bf16 v[80:95], a[140:143], a[100:103], v[80:95]
    ds_read_b64_tr_b16 a[152:153], v38 offset:22528
    ds_read_b64_tr_b16 a[154:155], v38 offset:23040
    v_mfma_f32_32x32x16_bf16 v[64:79], a[136:139], a[100:103], v[64:79]
    ds_read_b64_tr_b16 a[156:157], v39 offset:22528
    ds_read_b64_tr_b16 a[158:159], v39 offset:23040
    buffer_load_dwordx4 v21, s[16:19], s97 offen offset:1024 lds
    s_waitcnt lgkmcnt(8)
    v_mfma_f32_32x32x16_bf16 v[80:95], a[148:151], a[104:107], v[80:95]
    ds_read_b64_tr_b16 a[128:129], v38 offset:24576
    ds_read_b64_tr_b16 a[130:131], v38 offset:25088
    s_add_u32 m0, s59, 32768
    v_mfma_f32_32x32x16_bf16 v[64:79], a[144:147], a[104:107], v[64:79]
    ds_read_b64_tr_b16 a[132:133], v39 offset:24576
    ds_read_b64_tr_b16 a[134:135], v39 offset:25088
    s_waitcnt lgkmcnt(8)
    buffer_load_dwordx4 v20, s[16:19], s98 offen lds
    s_waitcnt lgkmcnt(4)
    v_mfma_f32_32x32x16_bf16 v[80:95], a[156:159], a[108:111], v[80:95]
    ds_read_b64_tr_b16 a[136:137], v38 offset:26624
    ds_read_b64_tr_b16 a[138:139], v38 offset:27136
    v_mfma_f32_32x32x16_bf16 v[64:79], a[152:155], a[108:111], v[64:79]
    ds_read_b64_tr_b16 a[140:141], v39 offset:26624
    ds_read_b64_tr_b16 a[142:143], v39 offset:27136
    buffer_load_dwordx4 v21, s[16:19], s98 offen offset:1024 lds
    s_waitcnt lgkmcnt(4)
    v_mfma_f32_32x32x16_bf16 v[80:95], a[132:135], a[112:115], v[80:95]
    ds_read_b64_tr_b16 a[144:145], v38 offset:28672
    ds_read_b64_tr_b16 a[146:147], v38 offset:29184
    s_add_u32 m0, s59, 34816
    v_mfma_f32_32x32x16_bf16 v[64:79], a[128:131], a[112:115], v[64:79]
    ds_read_b64_tr_b16 a[148:149], v39 offset:28672
    ds_read_b64_tr_b16 a[150:151], v39 offset:29184
    buffer_load_dwordx4 v20, s[16:19], s99 offen lds
    s_waitcnt lgkmcnt(4)
    v_mfma_f32_32x32x16_bf16 v[80:95], a[140:143], a[116:119], v[80:95]
    s_waitcnt lgkmcnt(0)
    s_cmp_lt_u32 s39, 4
    s_cbranch_scc1 L_retry_B_b0
L_back_B_b0:
    ds_read_b64_tr_b16 a[152:153], v38 offset:30720
    ds_read_b64_tr_b16 a[154:155], v38 offset:31232
    buffer_load_dwordx4 a[192:195], v28, s[24:27], s84 offen sc1
    v_mfma_f32_32x32x16_bf16 v[64:79], a[136:139], a[116:119], v[64:79]
    ds_read_b64_tr_b16 a[156:157], v39 offset:30720
    ds_read_b64_tr_b16 a[158:159], v39 offset:31232
    buffer_load_dwordx4 v21, s[16:19], s99 offen offset:1024 lds
    v_mfma_f32_32x32x16_bf16 v[80:95], a[148:151], a[120:123], v[80:95]
    buffer_load_dwordx4 a[196:199], v29, s[24:27], s84 offen sc1
    v_mfma_f32_32x32x16_bf16 v[64:79], a[144:147], a[120:123], v[64:79]
    buffer_load_dwordx4 a[200:203], v28, s[24:27], s85 offen sc1
    s_waitcnt lgkmcnt(0)
    v_mfma_f32_32x32x16_bf16 v[80:95], a[156:159], a[124:127], v[80:95]
    v_mfma_f32_32x32x16_bf16 v[64:79], a[152:155], a[124:127], v[64:79]
    buffer_load_dwordx4 a[204:207], v29, s[24:27], s85 offen sc1
    s_nop 10
    v_cvt_pk_bf16_f32 v224, v64, v65
    v_cvt_pk_bf16_f32 v225, v66, v67
    s_load_dword s40, s[24:25], s37 glc
    v_cvt_pk_bf16_f32 v226, v68, v69
    v_cvt_pk_bf16_f32 v227, v70, v71
    v_cvt_pk_bf16_f32 v228, v72, v73
    v_cvt_pk_bf16_f32 v229, v74, v75
    v_cvt_pk_bf16_f32 v230, v76, v77
    v_cvt_pk_bf16_f32 v231, v78, v79
    v_cvt_pk_bf16_f32 v232, v80, v81
    v_cvt_pk_bf16_f32 v233, v82, v83
    v_cvt_pk_bf16_f32 v234, v84, v85
    v_cvt_pk_bf16_f32 v235, v86, v87
    v_cvt_pk_bf16_f32 v236, v88, v89
    v_cvt_pk_bf16_f32 v237, v90, v91
    v_cvt_pk_bf16_f32 v238, v92, v93
    v_cvt_pk_bf16_f32 v239, v94, v95
    v_mfma_f32_32x32x16_bf16 v[192:207], a[168:171], v[224:227], 0
    v_mfma_f32_32x32x16_bf16 v[208:223], a[168:171], v[228:231], 0
    v_mfma_f32_32x32x16_bf16 v[64:79], a[172:175], v[232:235], 0
    v_mfma_f32_32x32x16_bf16 v[80:95], a[172:175], v[236:239], 0
    s_nop 8
    v_max3_f32 v240, v192, v193, v194
    v_max3_f32 v241, v216, v217, v218
    v_min3_f32 v242, v192, v193, v194
    v_min3_f32 v243, v216, v217, v218
    v_max3_f32 v240, v240, v195, v196
    v_max3_f32 v241, v241, v219, v220
    v_min3_f32 v242, v242, v195, v196
    v_min3_f32 v243, v243, v219, v220
    v_max3_f32 v240, v240, v197, v198
    v_max3_f32 v241, v241, v221, v222
    v_min3_f32 v242, v242, v197, v198
    v_min3_f32 v243, v243, v221, v222
    v_max_f32 v240, v240, v199
    v_max_f32 v241, v241, v223
    v_min_f32 v242, v242, v199
    v_min_f32 v243, v243, v223
    v_permlane32_swap_b32 v240, v241
    s_nop 0
    v_permlane32_swap_b32 v242, v243
    v_max_f32 v240, v240, v241
    v_mov_b32 v61, 1
    s_waitcnt vmcnt(12)
    s_mov_b64 exec, 1
    buffer_atomic_add v61, off, s[24:27], s36 offset:4 sc1
    s_mov_b64 exec, -1
    v_min_f32 v242, v242, v243
    v_mul_f32 v241, s51, v240
    v_mul_f32 v240, s51, v240
    v_mul_f32 v243, s51, v242
    v_mul_f32 v242, s51, v242
    v_permlane32_swap_b32 v240, v241
    s_nop 0
    v_permlane32_swap_b32 v242, v243
    v_fma_f32 v200, v192, -s51, v242
    v_fma_f32 v201, v193, -s51, v242
    v_fma_f32 v202, v194, -s51, v242
    v_fma_f32 v203, v195, -s51, v242
    v_fma_f32 v192, v192, s51, -v240
    v_fma_f32 v193, v193, s51, -v240
    v_fma_f32 v194, v194, s51, -v240
    v_fma_f32 v195, v195, s51, -v240
    v_exp_f32 v200, v200
    v_exp_f32 v201, v201
    v_exp_f32 v202, v202
    v_exp_f32 v203, v203
    v_exp_f32 v192, v192
    v_exp_f32 v193, v193
    v_exp_f32 v194, v194
    v_exp_f32 v195, v195
    v_fma_f32 v204, v196, -s51, v242
    v_fma_f32 v205, v197, -s51, v242
    v_fma_f32 v206, v198, -s51, v242
    v_fma_f32 v207, v199, -s51, v242
    v_fma_f32 v196, v196, s51, -v240
    v_fma_f32 v197, v197, s51, -v240
    v_fma_f32 v198, v198, s51, -v240
    v_fma_f32 v199, v199, s51, -v240
    v_exp_f32 v204, v204
    v_exp_f32 v205, v205
    v_exp_f32 v206, v206
    v_exp_f32 v207, v207
    v_exp_f32 v196, v196
    v_exp_f32 v197, v197
    v_exp_f32 v198, v198
    v_exp_f32 v199, v199
    v_fma_f32 v208, v216, -s51, v243
    v_fma_f32 v209, v217, -s51, v243
    v_fma_f32 v210, v218, -s51, v243
    v_fma_f32 v211, v219, -s51, v243
    v_fma_f32 v216, v216, s51, -v241
    v_fma_f32 v217, v217, s51, -v241
    v_fma_f32 v218, v218, s51, -v241
    v_fma_f32 v219, v219, s51, -v241
    v_exp_f32 v208, v208
    v_exp_f32 v209, v209
    v_exp_f32 v210, v210
    v_exp_f32 v211, v211
    v_exp_f32 v216, v216
    v_exp_f32 v217, v217
    v_exp_f32 v218, v218
    v_exp_f32 v219, v219
    v_fma_f32 v212, v220, -s51, v243
    v_fma_f32 v213, v221, -s51, v243
    v_fma_f32 v214, v222, -s51, v243
    v_fma_f32 v215, v223, -s51, v243
    v_fma_f32 v220, v220, s51, -v241
    v_fma_f32 v221, v221, s51, -v241
    v_fma_f32 v222, v222, s51, -v241
    s_waitcnt vmcnt(3)
    v_mfma_f32_32x32x16_bf16 a[48:63], v[132:135], a[196:199], 0
    buffer_load_dwordx4 a[208:211], v28, s[24:27], s86 offen sc1
    v_fma_f32 v223, v223, s51, -v241
    v_exp_f32 v212, v212
    v_exp_f32 v213, v213
    v_exp_f32 v214, v214
    v_exp_f32 v215, v215
    v_exp_f32 v220, v220
    v_exp_f32 v221, v221
    v_exp_f32 v222, v222
    v_exp_f32 v223, v223
    v_cvt_pk_bf16_f32 v96, v192, v193
    v_cvt_pk_bf16_f32 v97, v194, v195
    v_cvt_pk_bf16_f32 v98, v196, v197
    v_cvt_pk_bf16_f32 v99, v198, v199
    v_cvt_pk_bf16_f32 v100, v200, v201
    v_cvt_pk_bf16_f32 v101, v202, v203
    v_cvt_pk_bf16_f32 v102, v204, v205
    v_cvt_pk_bf16_f32 v103, v206, v207
    v_cvt_pk_bf16_f32 v104, v216, v217
    v_cvt_pk_bf16_f32 v105, v218, v219
    v_cvt_pk_bf16_f32 v106, v220, v221
    v_cvt_pk_bf16_f32 v107, v222, v223
    v_cvt_pk_bf16_f32 v108, v208, v209
    v_cvt_pk_bf16_f32 v109, v210, v211
    v_cvt_pk_bf16_f32 v110, v212, v213
    v_cvt_pk_bf16_f32 v111, v214, v215
    v_max3_f32 v240, v64, v65, v66
    v_max3_f32 v241, v88, v89, v90
    v_min3_f32 v242, v64, v65, v66
    v_min3_f32 v243, v88, v89, v90
    v_max3_f32 v240, v240, v67, v68
    v_max3_f32 v241, v241, v91, v92
    v_min3_f32 v242, v242, v67, v68
    v_min3_f32 v243, v243, v91, v92
    v_mfma_f32_32x32x16_bf16 a[32:47], v[128:131], a[196:199], 0
    v_max3_f32 v240, v240, v69, v70
    v_max3_f32 v241, v241, v93, v94
    v_min3_f32 v242, v242, v69, v70
    v_min3_f32 v243, v243, v93, v94
    v_max_f32 v240, v240, v71
    s_waitcnt lgkmcnt(0)
    s_cmp_lt_u32 s40, 16
    s_cbranch_scc1 L_retry_B_kv
L_back_B_kv:
    v_mfma_f32_32x32x16_bf16 a[16:31], v[132:135], a[192:195], 0
    buffer_load_dwordx4 a[212:215], v29, s[24:27], s86 offen sc1
    buffer_load_dword v248, v50, s[24:27], 0 offen offset:0 sc1
    buffer_load_dword v249, v50, s[24:27], 0 offen offset:128 sc1
    buffer_load_dword v250, v50, s[24:27], 0 offen offset:256 sc1
    buffer_load_dword v251, v50, s[24:27], 0 offen offset:384 sc1
    buffer_load_dword v252, v50, s[24:27], 0 offen offset:512 sc1
    buffer_load_dword v253, v50, s[24:27], 0 offen offset:640 sc1
    buffer_load_dword v254, v50, s[24:27], 0 offen offset:768 sc1
    buffer_load_dword v255, v50, s[24:27], 0 offen offset:896 sc1
    s_lshl_b32 s44, s60, 4
    buffer_load_dwordx4 a[64:67], v52, s[24:27], s44 offen offset:0 sc1
    buffer_load_dwordx4 a[68:71], v52, s[24:27], s44 offen offset:1024 sc1
    s_lshl_b32 s44, s61, 4
    buffer_load_dwordx4 a[72:75], v52, s[24:27], s44 offen offset:0 sc1
    buffer_load_dwordx4 a[76:79], v52, s[24:27], s44 offen offset:1024 sc1
    s_lshl_b32 s44, s62, 4
    buffer_load_dwordx4 a[80:83], v52, s[24:27], s44 offen offset:0 sc1
    buffer_load_dwordx4 a[84:87], v52, s[24:27], s44 offen offset:1024 sc1
    s_lshl_b32 s44, s63, 4
    buffer_load_dwordx4 a[88:91], v52, s[24:27], s44 offen offset:0 sc1
    buffer_load_dwordx4 a[92:95], v52, s[24:27], s44 offen offset:1024 sc1
    s_lshl_b32 s44, s64, 4
    buffer_load_dwordx4 a[96:99], v52, s[24:27], s44 offen offset:0 sc1
    buffer_load_dwordx4 a[100:103], v52, s[24:27], s44 offen offset:1024 sc1
    s_lshl_b32 s44, s65, 4
    buffer_load_dwordx4 a[104:107], v52, s[24:27], s44 offen offset:0 sc1
    buffer_load_dwordx4 a[108:111], v52, s[24:27], s44 offen offset:1024 sc1
    s_lshl_b32 s44, s66, 4
    buffer_load_dwordx4 a[112:115], v52, s[24:27], s44 offen offset:0 sc1
    buffer_load_dwordx4 a[116:119], v52, s[24:27], s44 offen offset:1024 sc1
    s_lshl_b32 s44, s67, 4
    buffer_load_dwordx4 a[120:123], v52, s[24:27], s44 offen offset:0 sc1
    buffer_load_dwordx4 a[124:127], v52, s[24:27], s44 offen offset:1024 sc1
    v_max_f32 v241, v241, v95
    v_min_f32 v242, v242, v71
    v_min_f32 v243, v243, v95
    v_permlane32_swap_b32 v240, v241
    s_nop 0
    v_permlane32_swap_b32 v242, v243
    v_mfma_f32_32x32x16_bf16 a[0:15], v[128:131], a[192:195], 0
    buffer_load_dwordx4 a[216:219], v28, s[24:27], s87 offen sc1
    v_max_f32 v240, v240, v241
    v_min_f32 v242, v242, v243
    v_mul_f32 v241, s51, v240
    v_mul_f32 v240, s51, v240
    v_mul_f32 v243, s51, v242
    v_mul_f32 v242, s51, v242
    v_permlane32_swap_b32 v240, v241
    s_nop 0
    v_permlane32_swap_b32 v242, v243
    v_fma_f32 v72, v64, -s51, v242
    v_fma_f32 v73, v65, -s51, v242
    v_fma_f32 v74, v66, -s51, v242
    v_fma_f32 v75, v67, -s51, v242
    v_fma_f32 v64, v64, s51, -v240
    v_fma_f32 v65, v65, s51, -v240
    v_fma_f32 v66, v66, s51, -v240
    v_fma_f32 v67, v67, s51, -v240
    v_exp_f32 v72, v72
    v_exp_f32 v73, v73
    v_exp_f32 v74, v74
    v_exp_f32 v75, v75
    v_exp_f32 v64, v64
    v_exp_f32 v65, v65
    v_exp_f32 v66, v66
    v_exp_f32 v67, v67
    v_fma_f32 v76, v68, -s51, v242
    v_fma_f32 v77, v69, -s51, v242
    v_fma_f32 v78, v70, -s51, v242
    v_fma_f32 v79, v71, -s51, v242
    v_fma_f32 v68, v68, s51, -v240
    v_fma_f32 v69, v69, s51, -v240
    s_add_u32 m0, s59, 0
    s_waitcnt vmcnt(28)
    v_mfma_f32_32x32x16_bf16 a[48:63], v[140:143], a[204:207], a[48:63]
    s_barrier
    s_load_dword s39, s[24:25], s38 offset:4 glc
    buffer_load_dwordx4 v22, s[16:19], s94 offen lds
    buffer_load_dwordx4 v23, s[16:19], s94 offen offset:1024 lds
    v_fma_f32 v70, v70, s51, -v240
    v_fma_f32 v71, v71, s51, -v240
    v_exp_f32 v76, v76
    v_exp_f32 v77, v77
    v_exp_f32 v78, v78
    v_exp_f32 v79, v79
    v_exp_f32 v68, v68
    v_exp_f32 v69, v69
    v_exp_f32 v70, v70
    v_exp_f32 v71, v71
    v_fma_f32 v80, v88, -s51, v243
    v_fma_f32 v81, v89, -s51, v243
    v_fma_f32 v82, v90, -s51, v243
    v_fma_f32 v83, v91, -s51, v243
    v_fma_f32 v88, v88, s51, -v241
    v_fma_f32 v89, v89, s51, -v241
    v_fma_f32 v90, v90, s51, -v241
    v_fma_f32 v91, v91, s51, -v241
    v_exp_f32 v80, v80
    v_exp_f32 v81, v81
    v_exp_f32 v82, v82
    v_exp_f32 v83, v83
    v_exp_f32 v88, v88
    v_exp_f32 v89, v89
    v_exp_f32 v90, v90
    v_exp_f32 v91, v91
    s_add_u32 m0, s59, 2048
    v_mfma_f32_32x32x16_bf16 a[32:47], v[136:139], a[204:207], a[32:47]
    buffer_load_dwordx4 v22, s[16:19], s95 offen lds
    buffer_load_dwordx4 v23, s[16:19], s95 offen offset:1024 lds
    buffer_load_dwordx4 a[220:223], v29, s[24:27], s87 offen sc1
    v_fma_f32 v84, v92, -s51, v243
    v_fma_f32 v85, v93, -s51, v243
    v_fma_f32 v86, v94, -s51, v243
    v_fma_f32 v87, v95, -s51, v243
    v_fma_f32 v92, v92, s51, -v241
    v_fma_f32 v93, v93, s51, -v241
    v_fma_f32 v94, v94, s51, -v241
    v_fma_f32 v95, v95, s51, -v241
    v_exp_f32 v84, v84
    v_exp_f32 v85, v85
    v_exp_f32 v86, v86
    v_exp_f32 v87, v87
    v_exp_f32 v92, v92
    v_exp_f32 v93, v93
    v_exp_f32 v94, v94
    v_exp_f32 v95, v95
    v_cvt_pk_bf16_f32 v112, v64, v65
    v_cvt_pk_bf16_f32 v113, v66, v67
    v_cvt_pk_bf16_f32 v114, v68, v69
    v_cvt_pk_bf16_f32 v115, v70, v71
    v_cvt_pk_bf16_f32 v116, v72, v73
    v_cvt_pk_bf16_f32 v117, v74, v75
    v_cvt_pk_bf16_f32 v118, v76, v77
    v_cvt_pk_bf16_f32 v119, v78, v79
    v_cvt_pk_bf16_f32 v120, v88, v89
    v_cvt_pk_bf16_f32 v121, v90, v91
    v_cvt_pk_bf16_f32 v122, v92, v93
    v_cvt_pk_bf16_f32 v123, v94, v95
    v_cvt_pk_bf16_f32 v124, v80, v81
    v_cvt_pk_bf16_f32 v125, v82, v83
    v_cvt_pk_bf16_f32 v126, v84, v85
    v_cvt_pk_bf16_f32 v127, v86, v87
    s_add_u32 m0, s59, 16384
    v_mfma_f32_32x32x16_bf16 a[16:31], v[140:143], a[200:203], a[16:31]
    buffer_load_dwordx4 v22, s[16:19], s96 offen lds
    buffer_load_dwordx4 v23, s[16:19], s96 offen offset:1024 lds
    buffer_load_dwordx4 a[224:227], v28, s[24:27], s88 offen sc1
    s_waitcnt vmcnt(24)
    v_mfma_f32_32x32x16_bf16 v[64:79], a[64:67], a[160:163], 0
    v_mov_b32 v245, 0
    v_mov_b32 v246, 0
    v_mov_b32 v247, 0
    s_waitcnt vmcnt(23)
    v_mfma_f32_32x32x16_bf16 v[64:79], a[68:71], a[160:163], v[64:79]
    v_lshl_add_u32 v2, s50, 11, v51
    v_add_f32 v248, v248, v249
    v_add_f32 v250, v250, v251
    s_waitcnt vmcnt(22)
    v_mfma_f32_32x32x16_bf16 v[64:79], a[72:75], a[160:163], v[64:79]
    v_add_f32 v252, v252, v253
    v_add_f32 v254, v254, v255
    v_add_f32 v248, v248, v250
    s_waitcnt vmcnt(21)
    v_mfma_f32_32x32x16_bf16 v[64:79], a[76:79], a[160:163], v[64:79]
    v_add_f32 v252, v252, v254
    v_add_f32 v249, v248, v252
    v_add_f32 v248, v248, v252
    s_waitcnt vmcnt(20)
    v_mfma_f32_32x32x16_bf16 v[64:79], a[80:83], a[160:163], v[64:79]
    s_add_u32 m0, s59, 18432
    v_mfma_f32_32x32x16_bf16 a[0:15], v[136:139], a[200:203], a[0:15]
    buffer_load_dwordx4 v22, s[16:19], s97 offen lds
    buffer_load_dwordx4 v23, s[16:19], s97 offen offset:1024 lds
    v_permlane32_swap_b32 v248, v249
    v_add_f32 v248, v248, v249
    s_waitcnt vmcnt(21)
    v_mfma_f32_32x32x16_bf16 v[64:79], a[84:87], a[160:163], v[64:79]
    v_cvt_pk_bf16_f32 v244, v248, 1.0
    s_waitcnt vmcnt(20)
    v_mfma_f32_32x32x16_bf16 v[64:79], a[88:91], a[160:163], v[64:79]
    s_waitcnt vmcnt(19)
    v_mfma_f32_32x32x16_bf16 v[64:79], a[92:95], a[160:163], v[64:79]
    s_waitcnt vmcnt(18)
    v_mfma_f32_32x32x16_bf16 v[64:79], a[96:99], a[160:163], v[64:79]
    s_waitcnt vmcnt(17)
    v_mfma_f32_32x32x16_bf16 v[64:79], a[100:103], a[160:163], v[64:79]
    s_waitcnt vmcnt(16)
    v_mfma_f32_32x32x16_bf16 v[64:79], a[104:107], a[160:163], v[64:79]
    v_mfma_f32_32x32x16_bf16 a[48:63], v[148:151], a[212:215], a[48:63]
    buffer_load_dwordx4 a[228:231], v29, s[24:27], s88 offen sc1
    s_waitcnt vmcnt(16)
    v_mfma_f32_32x32x16_bf16 v[64:79], a[108:111], a[160:163], v[64:79]
    s_waitcnt vmcnt(15)
    v_mfma_f32_32x32x16_bf16 v[64:79], a[112:115], a[160:163], v[64:79]
    s_waitcnt vmcnt(14)
    v_mfma_f32_32x32x16_bf16 v[64:79], a[116:119], a[160:163], v[64:79]
    s_waitcnt vmcnt(13)
    v_mfma_f32_32x32x16_bf16 v[64:79], a[120:123], a[160:163], v[64:79]
    s_waitcnt vmcnt(12)
    v_mfma_f32_32x32x16_bf16 v[64:79], a[124:127], a[160:163], v[64:79]
    v_mfma_f32_32x32x16_bf16 v[64:79], v[244:247], a[164:167], v[64:79]
    v_mfma_f32_32x32x16_bf16 a[32:47], v[144:147], a[212:215], a[32:47]
    buffer_load_dwordx4 a[232:235], v28, s[24:27], s89 offen sc1
    s_nop 9
    v_cvt_pk_bf16_f32 v192, v64, v65
    v_cvt_pk_bf16_f32 v193, v66, v67
    v_cvt_pk_bf16_f32 v194, v68, v69
    v_cvt_pk_bf16_f32 v195, v70, v71
    v_cvt_pk_bf16_f32 v196, v72, v73
    v_cvt_pk_bf16_f32 v197, v74, v75
    v_cvt_pk_bf16_f32 v198, v76, v77
    v_cvt_pk_bf16_f32 v199, v78, v79
    v_mfma_f32_32x32x16_bf16 a[16:31], v[148:151], a[208:211], a[16:31]
    ds_write_b128 v2, v[192:195]
    ds_write_b128 v2, v[196:199] offset:1024
    v_mfma_f32_32x32x16_bf16 a[0:15], v[144:147], a[208:211], a[0:15]
    buffer_load_dwordx4 a[236:239], v29, s[24:27], s89 offen sc1
    s_waitcnt lgkmcnt(0)
    s_barrier
    ds_read_b128 a[160:163], v51 offset:0
    ds_read_b128 a[164:167], v51 offset:1024
    ds_read_b128 a[168:171], v51 offset:2048
    ds_read_b128 a[172:175], v51 offset:3072
    ds_read_b128 a[176:179], v51 offset:4096
    ds_read_b128 a[180:183], v51 offset:5120
    ds_read_b128 a[184:187], v51 offset:6144
    ds_read_b128 a[188:191], v51 offset:7168
    s_waitcnt vmcnt(8)
    v_mfma_f32_32x32x16_bf16 a[48:63], v[156:159], a[220:223], a[48:63]
    buffer_load_dwordx4 a[240:243], v28, s[24:27], s90 offen sc1
    s_waitcnt lgkmcnt(7)
    v_mfma_f32_32x32x16_bf16 v[64:79], a[160:163], v[96:99], 0
    v_mfma_f32_32x32x16_bf16 a[32:47], v[152:155], a[220:223], a[32:47]
    s_waitcnt lgkmcnt(6)
    v_mfma_f32_32x32x16_bf16 v[80:95], a[164:167], v[100:103], 0
    s_waitcnt lgkmcnt(5)
    v_mfma_f32_32x32x16_bf16 v[192:207], a[168:171], v[104:107], 0
    v_mfma_f32_32x32x16_bf16 a[16:31], v[156:159], a[216:219], a[16:31]
    buffer_load_dwordx4 a[244:247], v29, s[24:27], s90 offen sc1
    s_waitcnt lgkmcnt(4)
    v_mfma_f32_32x32x16_bf16 v[208:223], a[172:175], v[108:111], 0
    v_mfma_f32_32x32x16_bf16 a[0:15], v[152:155], a[216:219], a[0:15]
    buffer_load_dwordx4 a[248:251], v28, s[24:27], s91 offen sc1
    s_nop 3
    v_mul_f32 v224, v72, v92
    v_mul_f32 v225, v76, v92
    v_fmac_f32 v224, v88, v76
    v_fmac_f32 v224, 0x358637bd, v225
    v_rcp_f32 v224, v224
    v_mul_f32 v225, v54, v92
    v_mul_f32 v226, v54, v76
    v_mul_f32 v225, v224, v225
    v_mul_f32 v226, v224, v226
    s_waitcnt vmcnt(5)
    v_mfma_f32_32x32x16_bf16 a[48:63], v[164:167], a[228:231], a[48:63]
    s_waitcnt lgkmcnt(0)
    s_cmp_lt_u32 s39, 4
    s_cbranch_scc1 L_retry_B_b1
L_back_B_b1:
    v_mul_f32 v64, v225, v64
    v_mul_f32 v65, v225, v65
    v_mul_f32 v66, v225, v66
    v_mul_f32 v67, v225, v67
    v_mul_f32 v68, v225, v68
    v_mul_f32 v69, v225, v69
    v_mul_f32 v70, v225, v70
    v_mul_f32 v71, v225, v71
    v_fmac_f32 v64, v226, v80
    v_fmac_f32 v65, v226, v81
    v_mfma_f32_32x32x16_bf16 a[32:47], v[160:163], a[228:231], a[32:47]
    buffer_load_dwordx4 a[252:255], v29, s[24:27], s91 offen sc1
    v_fmac_f32 v66, v226, v82
    v_fmac_f32 v67, v226, v83
    v_fmac_f32 v68, v226, v84
    v_fmac_f32 v69, v226, v85
    v_fmac_f32 v70, v226, v86
    v_fmac_f32 v71, v226, v87
    v_cvt_pk_bf16_f32 v240, v64, v65
    v_cvt_pk_bf16_f32 v241, v66, v67
    v_cvt_pk_bf16_f32 v242, v68, v69
    v_cvt_pk_bf16_f32 v243, v70, v71
    v_mfma_f32_32x32x16_bf16 a[16:31], v[164:167], a[224:227], a[16:31]
    buffer_load_dwordx4 a[192:195], v30, s[24:27], s84 offen sc1
    v_mfma_f32_32x32x16_bf16 v[64:79], a[176:179], v[112:115], 0
    v_mfma_f32_32x32x16_bf16 a[0:15], v[160:163], a[224:227], a[0:15]
    v_mfma_f32_32x32x16_bf16 v[80:95], a[180:183], v[116:119], 0
    v_mul_f32 v224, v200, v220
    v_mul_f32 v225, v204, v220
    v_fmac_f32 v224, v216, v204
    v_fmac_f32 v224, 0x358637bd, v225
    s_waitcnt vmcnt(5)
    v_mfma_f32_32x32x16_bf16 a[48:63], v[172:175], a[236:239], a[48:63]
    buffer_load_dwordx4 a[196:199], v31, s[24:27], s84 offen sc1
    v_rcp_f32 v224, v224
    v_mul_f32 v225, v54, v220
    v_mul_f32 v226, v54, v204
    v_mul_f32 v225, v224, v225
    v_mul_f32 v226, v224, v226
    v_mul_f32 v192, v225, v192
    v_mul_f32 v193, v225, v193
    v_mul_f32 v194, v225, v194
    v_mul_f32 v195, v225, v195
    v_mfma_f32_32x32x16_bf16 a[32:47], v[168:171], a[236:239], a[32:47]
    buffer_load_dwordx4 a[200:203], v30, s[24:27], s85 offen sc1
    v_mul_f32 v196, v225, v196
    v_mul_f32 v197, v225, v197
    v_mul_f32 v198, v225, v198
    v_mul_f32 v199, v225, v199
    v_fmac_f32 v192, v226, v208
    v_fmac_f32 v193, v226, v209
    v_fmac_f32 v194, v226, v210
    v_fmac_f32 v195, v226, v211
    v_fmac_f32 v196, v226, v212
    v_fmac_f32 v197, v226, v213
    v_fmac_f32 v198, v226, v214
    v_mfma_f32_32x32x16_bf16 a[16:31], v[172:175], a[232:235], a[16:31]
    v_fmac_f32 v199, v226, v215
    v_cvt_pk_bf16_f32 v244, v192, v193
    v_cvt_pk_bf16_f32 v245, v194, v195
    v_cvt_pk_bf16_f32 v246, v196, v197
    v_cvt_pk_bf16_f32 v247, v198, v199
    v_mfma_f32_32x32x16_bf16 v[192:207], a[184:187], v[120:123], 0
    v_mfma_f32_32x32x16_bf16 a[0:15], v[168:171], a[232:235], a[0:15]
    buffer_load_dwordx4 a[204:207], v31, s[24:27], s85 offen sc1
    v_mfma_f32_32x32x16_bf16 v[208:223], a[188:191], v[124:127], 0
    s_waitcnt vmcnt(6)
    v_mfma_f32_32x32x16_bf16 a[48:63], v[180:183], a[244:247], a[48:63]
    ds_read_b64_tr_b16 a[128:129], v44 offset:49152
    ds_read_b64_tr_b16 a[130:131], v44 offset:50176
    buffer_load_dwordx4 a[208:211], v30, s[24:27], s86 offen sc1
    v_mul_f32 v224, v72, v92
    v_mul_f32 v225, v76, v92
    v_fmac_f32 v224, v88, v76
    v_fmac_f32 v224, 0x358637bd, v225
    v_rcp_f32 v224, v224
    v_mul_f32 v225, v54, v92
    v_mul_f32 v226, v54, v76
    v_mul_f32 v225, v224, v225
    v_mfma_f32_32x32x16_bf16 a[32:47], v[176:179], a[244:247], a[32:47]
    ds_read_b64_tr_b16 a[132:133], v45 offset:49152
    ds_read_b64_tr_b16 a[134:135], v45 offset:50176
    v_mul_f32 v226, v224, v226
    v_mul_f32 v64, v225, v64
    v_mul_f32 v65, v225, v65
    v_mul_f32 v66, v225, v66
    v_mul_f32 v67, v225, v67
    v_mul_f32 v68, v225, v68
    v_mul_f32 v69, v225, v69
    v_mul_f32 v70, v225, v70
    v_mul_f32 v71, v225, v71
    v_fmac_f32 v64, v226, v80
    v_mfma_f32_32x32x16_bf16 a[16:31], v[180:183], a[240:243], a[16:31]
    buffer_load_dwordx4 a[212:215], v31, s[24:27], s86 offen sc1
    v_fmac_f32 v65, v226, v81
    v_fmac_f32 v66, v226, v82
    v_fmac_f32 v67, v226, v83
    v_fmac_f32 v68, v226, v84
    v_fmac_f32 v69, v226, v85
    v_fmac_f32 v70, v226, v86
    v_fmac_f32 v71, v226, v87
    v_cvt_pk_bf16_f32 v248, v64, v65
    v_cvt_pk_bf16_f32 v249, v66, v67
    v_cvt_pk_bf16_f32 v250, v68, v69
    v_mfma_f32_32x32x16_bf16 a[0:15], v[176:179], a[240:243], a[0:15]
    buffer_load_dwordx4 a[216:219], v30, s[24:27], s87 offen sc1
    v_cvt_pk_bf16_f32 v251, v70, v71
    v_mul_f32 v224, v200, v220
    v_mul_f32 v225, v204, v220
    v_fmac_f32 v224, v216, v204
    v_fmac_f32 v224, 0x358637bd, v225
    v_rcp_f32 v224, v224
    v_mul_f32 v225, v54, v220
    v_mul_f32 v226, v54, v204
    v_mul_f32 v225, v224, v225
    v_mul_f32 v226, v224, v226
    s_waitcnt vmcnt(7)
    v_mfma_f32_32x32x16_bf16 a[48:63], v[188:191], a[252:255], a[48:63]
    ds_read_b64_tr_b16 a[136:137], v44 offset:51200
    ds_read_b64_tr_b16 a[138:139], v44 offset:52224
    v_mul_f32 v192, v225, v192
    v_mul_f32 v193, v225, v193
    v_mul_f32 v194, v225, v194
    v_mul_f32 v195, v225, v195
    v_mul_f32 v196, v225, v196
    v_mul_f32 v197, v225, v197
    v_mul_f32 v198, v225, v198
    v_mul_f32 v199, v225, v199
    v_fmac_f32 v192, v226, v208
    v_fmac_f32 v193, v226, v209
    v_mfma_f32_32x32x16_bf16 a[32:47], v[184:187], a[252:255], a[32:47]
    ds_read_b64_tr_b16 a[140:141], v45 offset:51200
    ds_read_b64_tr_b16 a[142:143], v45 offset:52224
    buffer_load_dwordx4 a[220:223], v31, s[24:27], s87 offen sc1
    v_fmac_f32 v194, v226, v210
    v_fmac_f32 v195, v226, v211
    v_fmac_f32 v196, v226, v212
    v_fmac_f32 v197, v226, v213
    v_fmac_f32 v198, v226, v214
    v_fmac_f32 v199, v226, v215
    v_cvt_pk_bf16_f32 v252, v192, v193
    v_cvt_pk_bf16_f32 v253, v194, v195
    v_cvt_pk_bf16_f32 v254, v196, v197
    v_cvt_pk_bf16_f32 v255, v198, v199
    v_mfma_f32_32x32x16_bf16 a[16:31], v[188:191], a[248:251], a[16:31]
    buffer_load_dwordx4 a[224:227], v30, s[24:27], s88 offen sc1
    buffer_store_dwordx4 v[240:243], v6, s[24:27], 0 offen offset:0 sc1
    buffer_store_dwordx4 v[244:247], v6, s[24:27], 0 offen offset:1024 sc1
    buffer_store_dwordx4 v[248:251], v6, s[24:27], 0 offen offset:2048 sc1
    buffer_store_dwordx4 v[252:255], v6, s[24:27], 0 offen offset:3072 sc1
    v_mfma_f32_32x32x16_bf16 a[0:15], v[184:187], a[248:251], a[0:15]
    s_waitcnt vmcnt(11) lgkmcnt(4)
    v_mfma_f32_32x32x16_bf16 a[48:63], a[132:135], a[196:199], a[48:63]
    ds_read_b64_tr_b16 a[144:145], v46 offset:49152
    ds_read_b64_tr_b16 a[146:147], v46 offset:50176
    s_load_dword s39, s[24:25], s38 offset:8 glc
    buffer_load_dwordx4 a[228:231], v31, s[24:27], s88 offen sc1
    v_mfma_f32_32x32x16_bf16 a[32:47], a[128:131], a[196:199], a[32:47]
    ds_read_b64_tr_b16 a[148:149], v47 offset:49152
    ds_read_b64_tr_b16 a[150:151], v47 offset:50176
    buffer_load_dwordx4 a[232:235], v30, s[24:27], s89 offen sc1
    v_mfma_f32_32x32x16_bf16 a[16:31], a[132:135], a[192:195], a[16:31]
    v_mfma_f32_32x32x16_bf16 a[0:15], a[128:131], a[192:195], a[0:15]
    buffer_load_dwordx4 a[236:239], v31, s[24:27], s89 offen sc1
    s_waitcnt vmcnt(12) lgkmcnt(4)
    v_mfma_f32_32x32x16_bf16 a[48:63], a[140:143], a[204:207], a[48:63]
    ds_read_b64_tr_b16 a[152:153], v46 offset:51200
    ds_read_b64_tr_b16 a[154:155], v46 offset:52224
    buffer_load_dwordx4 a[240:243], v30, s[24:27], s90 offen sc1
    v_mfma_f32_32x32x16_bf16 a[32:47], a[136:139], a[204:207], a[32:47]
    ds_read_b64_tr_b16 a[156:157], v47 offset:51200
    ds_read_b64_tr_b16 a[158:159], v47 offset:52224
    v_mfma_f32_32x32x16_bf16 a[16:31], a[140:143], a[200:203], a[16:31]
    buffer_load_dwordx4 a[244:247], v31, s[24:27], s90 offen sc1
    v_mfma_f32_32x32x16_bf16 a[0:15], a[136:139], a[200:203], a[0:15]
    buffer_load_dwordx4 a[248:251], v30, s[24:27], s91 offen sc1
    s_add_u32 m0, s59, 49152
    s_waitcnt vmcnt(13) lgkmcnt(4)
    v_mfma_f32_32x32x16_bf16 a[48:63], a[148:151], a[212:215], a[48:63]
    ds_read_b64_tr_b16 a[128:129], v48 offset:0
    ds_read_b64_tr_b16 a[130:131], v48 offset:1024
    buffer_load_dwordx4 v22, s[16:19], s98 offen lds
    buffer_load_dwordx4 v23, s[16:19], s98 offen offset:1024 lds
    s_add_u32 m0, s59, 51200
    v_mfma_f32_32x32x16_bf16 a[32:47], a[144:147], a[212:215], a[32:47]
    ds_read_b64_tr_b16 a[132:133], v49 offset:0
    ds_read_b64_tr_b16 a[134:135], v49 offset:1024
    buffer_load_dwordx4 v22, s[16:19], s99 offen lds
    buffer_load_dwordx4 v23, s[16:19], s99 offen offset:1024 lds
    buffer_load_dwordx4 a[252:255], v31, s[24:27], s91 offen sc1
    v_mfma_f32_32x32x16_bf16 a[16:31], a[148:151], a[208:211], a[16:31]
    v_mfma_f32_32x32x16_bf16 a[0:15], a[144:147], a[208:211], a[0:15]
    s_waitcnt vmcnt(16) lgkmcnt(4)
    v_mfma_f32_32x32x16_bf16 a[48:63], a[156:159], a[220:223], a[48:63]
    s_waitcnt lgkmcnt(0)
    s_cmp_lt_u32 s39, 4
    s_cbranch_scc1 L_retry_B_a0
L_back_B_a0:
    ds_read_b64_tr_b16 a[136:137], v48 offset:2048
    ds_read_b64_tr_b16 a[138:139], v48 offset:3072
    buffer_load_dwordx4 a[192:195], v32, s[24:27], s84 offen sc1
    v_mfma_f32_32x32x16_bf16 a[32:47], a[152:155], a[220:223], a[32:47]
    ds_read_b64_tr_b16 a[140:141], v49 offset:2048
    ds_read_b64_tr_b16 a[142:143], v49 offset:3072
    v_mfma_f32_32x32x16_bf16 a[16:31], a[156:159], a[216:219], a[16:31]
    buffer_load_dwordx4 a[196:199], v33, s[24:27], s84 offen sc1
    v_mfma_f32_32x32x16_bf16 a[0:15], a[152:155], a[216:219], a[0:15]
    buffer_load_dwordx4 a[200:203], v32, s[24:27], s85 offen sc1
    s_add_u32 m0, s59, 114688
    s_and_b32 s54, s94, 0xc000
    s_waitcnt vmcnt(13)
    v_mfma_f32_32x32x16_bf16 a[48:63], a[132:135], a[228:231], a[48:63]
    ds_read_b64_tr_b16 a[144:145], v44 offset:32768
    ds_read_b64_tr_b16 a[146:147], v44 offset:33792
    buffer_load_dwordx4 v24, s[16:19], s54 offen lds
    buffer_load_dwordx4 v25, s[16:19], s54 offen offset:1024 lds
    s_add_u32 m0, s59, 116736
    s_and_b32 s54, s95, 0xc000
    v_mfma_f32_32x32x16_bf16 a[32:47], a[128:131], a[228:231], a[32:47]
    ds_read_b64_tr_b16 a[148:149], v45 offset:32768
    ds_read_b64_tr_b16 a[150:151], v45 offset:33792
    buffer_load_dwordx4 v24, s[16:19], s54 offen lds
    buffer_load_dwordx4 v25, s[16:19], s54 offen offset:1024 lds
    buffer_load_dwordx4 a[204:207], v33, s[24:27], s85 offen sc1
    v_mfma_f32_32x32x16_bf16 a[16:31], a[132:135], a[224:227], a[16:31]
    buffer_load_dwordx4 a[208:211], v32, s[24:27], s86 offen sc1
    v_mfma_f32_32x32x16_bf16 a[0:15], a[128:131], a[224:227], a[0:15]
    s_waitcnt vmcnt(17) lgkmcnt(4)
    v_mfma_f32_32x32x16_bf16 a[48:63], a[140:143], a[236:239], a[48:63]
    ds_read_b64_tr_b16 a[152:153], v44 offset:34816
    ds_read_b64_tr_b16 a[154:155], v44 offset:35840
    buffer_load_dwordx4 a[212:215], v33, s[24:27], s86 offen sc1
    v_mfma_f32_32x32x16_bf16 a[32:47], a[136:139], a[236:239], a[32:47]
    ds_read_b64_tr_b16 a[156:157], v45 offset:34816
    ds_read_b64_tr_b16 a[158:159], v45 offset:35840
    buffer_load_dwordx4 a[216:219], v32, s[24:27], s87 offen sc1
    v_mfma_f32_32x32x16_bf16 a[16:31], a[140:143], a[232:235], a[16:31]
    v_mfma_f32_32x32x16_bf16 a[0:15], a[136:139], a[232:235], a[0:15]
    buffer_load_dwordx4 a[220:223], v33, s[24:27], s87 offen sc1
    v_mov_b32 v61, 1
    s_add_u32 m0, s59, 131072
    s_lshl_b32 s54, s86, 4
    s_waitcnt vmcnt(18) lgkmcnt(4)
    v_mfma_f32_32x32x16_bf16 a[48:63], a[148:151], a[244:247], a[48:63]
    ds_read_b64_tr_b16 a[128:129], v46 offset:0
    ds_read_b64_tr_b16 a[130:131], v46 offset:1024
    buffer_load_dwordx4 v26, s[20:23], s54 offen lds
    buffer_load_dwordx4 v27, s[20:23], s54 offen offset:1024 lds
    buffer_load_dwordx4 a[224:227], v32, s[24:27], s88 offen sc1
    s_mov_b64 exec, 1
    buffer_atomic_add v61, off, s[24:27], s36 offset:12 sc1
    s_mov_b64 exec, -1
    s_add_u32 m0, s59, 133120
    s_lshl_b32 s54, s87, 4
    v_mfma_f32_32x32x16_bf16 a[32:47], a[144:147], a[244:247], a[32:47]
    ds_read_b64_tr_b16 a[132:133], v47 offset:0
    ds_read_b64_tr_b16 a[134:135], v47 offset:1024
    buffer_load_dwordx4 v26, s[20:23], s54 offen lds
    buffer_load_dwordx4 v27, s[20:23], s54 offen offset:1024 lds
    v_mfma_f32_32x32x16_bf16 a[16:31], a[148:151], a[240:243], a[16:31]
    buffer_load_dwordx4 a[228:231], v33, s[24:27], s88 offen sc1
    v_mfma_f32_32x32x16_bf16 a[0:15], a[144:147], a[240:243], a[0:15]
    s_waitcnt vmcnt(19) lgkmcnt(4)
    v_mfma_f32_32x32x16_bf16 a[48:63], a[156:159], a[252:255], a[48:63]
    ds_read_b64_tr_b16 a[136:137], v46 offset:2048
    ds_read_b64_tr_b16 a[138:139], v46 offset:3072
    buffer_load_dwordx4 a[232:235], v32, s[24:27], s89 offen sc1
    v_mfma_f32_32x32x16_bf16 a[32:47], a[152:155], a[252:255], a[32:47]
    ds_read_b64_tr_b16 a[140:141], v47 offset:2048
    ds_read_b64_tr_b16 a[142:143], v47 offset:3072
    v_mfma_f32_32x32x16_bf16 a[16:31], a[156:159], a[248:251], a[16:31]
    buffer_load_dwordx4 a[236:239], v33, s[24:27], s89 offen sc1
    v_mfma_f32_32x32x16_bf16 a[0:15], a[152:155], a[248:251], a[0:15]
    s_add_u32 m0, s59, 32768
    s_lshl_b32 s54, s88, 4
    s_waitcnt vmcnt(19) lgkmcnt(4)
    v_mfma_f32_32x32x16_bf16 a[48:63], a[132:135], a[196:199], a[48:63]
    ds_read_b64_tr_b16 a[144:145], v44 offset:0
    ds_read_b64_tr_b16 a[146:147], v44 offset:1024
    buffer_load_dwordx4 v26, s[20:23], s54 offen lds
    buffer_load_dwordx4 v27, s[20:23], s54 offen offset:1024 lds
    buffer_load_dwordx4 a[240:243], v32, s[24:27], s90 offen sc1
    s_add_u32 m0, s59, 34816
    s_lshl_b32 s54, s89, 4
    v_mfma_f32_32x32x16_bf16 a[32:47], a[128:131], a[196:199], a[32:47]
    ds_read_b64_tr_b16 a[148:149], v45 offset:0
    ds_read_b64_tr_b16 a[150:151], v45 offset:1024
    buffer_load_dwordx4 v26, s[20:23], s54 offen lds
    buffer_load_dwordx4 v27, s[20:23], s54 offen offset:1024 lds
    v_mfma_f32_32x32x16_bf16 a[16:31], a[132:135], a[192:195], a[16:31]
    buffer_load_dwordx4 a[244:247], v33, s[24:27], s90 offen sc1
    v_mfma_f32_32x32x16_bf16 a[0:15], a[128:131], a[192:195], a[0:15]
    s_waitcnt vmcnt(19) lgkmcnt(4)
    v_mfma_f32_32x32x16_bf16 a[48:63], a[140:143], a[204:207], a[48:63]
    ds_read_b64_tr_b16 a[152:153], v44 offset:2048
    ds_read_b64_tr_b16 a[154:155], v44 offset:3072
    buffer_load_dwordx4 a[248:251], v32, s[24:27], s91 offen sc1
    v_mfma_f32_32x32x16_bf16 a[32:47], a[136:139], a[204:207], a[32:47]
    ds_read_b64_tr_b16 a[156:157], v45 offset:2048
    ds_read_b64_tr_b16 a[158:159], v45 offset:3072
    v_mfma_f32_32x32x16_bf16 a[16:31], a[140:143], a[200:203], a[16:31]
    buffer_load_dwordx4 a[252:255], v33, s[24:27], s91 offen sc1
    v_mfma_f32_32x32x16_bf16 a[0:15], a[136:139], a[200:203], a[0:15]
    s_add_u32 m0, s59, 65536
    s_lshl_b32 s54, s90, 4
    s_and_b32 s53, s84, 0xc00
    s_waitcnt vmcnt(19) lgkmcnt(4)
    v_mfma_f32_32x32x16_bf16 a[48:63], a[148:151], a[212:215], a[48:63]
    ds_read_b64_tr_b16 a[128:129], v44 offset:16384
    ds_read_b64_tr_b16 a[130:131], v44 offset:17408
    buffer_load_dwordx4 v26, s[20:23], s54 offen lds
    buffer_load_dwordx4 v27, s[20:23], s54 offen offset:1024 lds
    buffer_load_dwordx4 a[192:195], v34, s[24:27], s53 offen sc1
    s_add_u32 m0, s59, 67584
    s_lshl_b32 s54, s91, 4
    v_mfma_f32_32x32x16_bf16 a[32:47], a[144:147], a[212:215], a[32:47]
    ds_read_b64_tr_b16 a[132:133], v45 offset:16384
    ds_read_b64_tr_b16 a[134:135], v45 offset:17408
    buffer_load_dwordx4 v26, s[20:23], s54 offen lds
    buffer_load_dwordx4 v27, s[20:23], s54 offen offset:1024 lds
    v_mfma_f32_32x32x16_bf16 a[16:31], a[148:151], a[208:211], a[16:31]
    buffer_load_dwordx4 a[196:199], v35, s[24:27], s53 offen sc1
    v_mfma_f32_32x32x16_bf16 a[0:15], a[144:147], a[208:211], a[0:15]
    s_and_b32 s53, s85, 0xc00
    s_waitcnt vmcnt(23) lgkmcnt(4)
    v_mfma_f32_32x32x16_bf16 a[48:63], a[156:159], a[220:223], a[48:63]
    ds_read_b64_tr_b16 a[136:137], v44 offset:18432
    ds_read_b64_tr_b16 a[138:139], v44 offset:19456
    buffer_load_dwordx4 a[200:203], v34, s[24:27], s53 offen sc1
    v_mfma_f32_32x32x16_bf16 a[32:47], a[152:155], a[220:223], a[32:47]
    ds_read_b64_tr_b16 a[140:141], v45 offset:18432
    ds_read_b64_tr_b16 a[142:143], v45 offset:19456
    v_mfma_f32_32x32x16_bf16 a[16:31], a[156:159], a[216:219], a[16:31]
    buffer_load_dwordx4 a[204:207], v35, s[24:27], s53 offen sc1
    v_mfma_f32_32x32x16_bf16 a[0:15], a[152:155], a[216:219], a[0:15]
    s_and_b32 s53, s86, 0xc00
    s_waitcnt vmcnt(18) lgkmcnt(4)
    v_mfma_f32_32x32x16_bf16 a[48:63], a[132:135], a[228:231], a[48:63]
    ds_read_b64_tr_b16 a[144:145], v44 offset:49152
    ds_read_b64_tr_b16 a[146:147], v44 offset:50176
    buffer_load_dwordx4 a[208:211], v34, s[24:27], s53 offen sc1
    v_mfma_f32_32x32x16_bf16 a[32:47], a[128:131], a[228:231], a[32:47]
    ds_read_b64_tr_b16 a[148:149], v45 offset:49152
    ds_read_b64_tr_b16 a[150:151], v45 offset:50176
    v_mfma_f32_32x32x16_bf16 a[16:31], a[132:135], a[224:227], a[16:31]
    buffer_load_dwordx4 a[212:215], v35, s[24:27], s53 offen sc1
    v_mfma_f32_32x32x16_bf16 a[0:15], a[128:131], a[224:227], a[0:15]
    s_and_b32 s53, s87, 0xc00
    s_waitcnt vmcnt(18) lgkmcnt(4)
    v_mfma_f32_32x32x16_bf16 a[48:63], a[140:143], a[236:239], a[48:63]
    ds_read_b64_tr_b16 a[152:153], v44 offset:51200
    ds_read_b64_tr_b16 a[154:155], v44 offset:52224
    s_load_dword s39, s[24:25], s38 offset:12 glc
    buffer_load_dwordx4 a[216:219], v34, s[24:27], s53 offen sc1
    v_mfma_f32_32x32x16_bf16 a[32:47], a[136:139], a[236:239], a[32:47]
    ds_read_b64_tr_b16 a[156:157], v45 offset:51200
    ds_read_b64_tr_b16 a[158:159], v45 offset:52224
    v_mfma_f32_32x32x16_bf16 a[16:31], a[140:143], a[232:235], a[16:31]
    buffer_load_dwordx4 a[220:223], v35, s[24:27], s53 offen sc1
    v_mfma_f32_32x32x16_bf16 a[0:15], a[136:139], a[232:235], a[0:15]
    s_waitcnt vmcnt(14) lgkmcnt(4)
    v_mfma_f32_32x32x16_bf16 a[48:63], a[148:151], a[244:247], a[48:63]
    ds_read_b64_tr_b16 a[128:129], v46 offset:32768
    ds_read_b64_tr_b16 a[130:131], v46 offset:33792
    v_mfma_f32_32x32x16_bf16 a[32:47], a[144:147], a[244:247], a[32:47]
    ds_read_b64_tr_b16 a[132:133], v47 offset:32768
    ds_read_b64_tr_b16 a[134:135], v47 offset:33792
    v_mfma_f32_32x32x16_bf16 a[16:31], a[148:151], a[240:243], a[16:31]
    v_mfma_f32_32x32x16_bf16 a[0:15], a[144:147], a[240:243], a[0:15]
    s_waitcnt vmcnt(12) lgkmcnt(4)
    v_mfma_f32_32x32x16_bf16 a[48:63], a[156:159], a[252:255], a[48:63]
    ds_read_b64_tr_b16 a[136:137], v46 offset:34816
    ds_read_b64_tr_b16 a[138:139], v46 offset:35840
    v_mfma_f32_32x32x16_bf16 a[32:47], a[152:155], a[252:255], a[32:47]
    ds_read_b64_tr_b16 a[140:141], v47 offset:34816
    ds_read_b64_tr_b16 a[142:143], v47 offset:35840
    v_mfma_f32_32x32x16_bf16 a[16:31], a[156:159], a[248:251], a[16:31]
    v_mfma_f32_32x32x16_bf16 a[0:15], a[152:155], a[248:251], a[0:15]
    s_waitcnt vmcnt(6) lgkmcnt(4)
    v_mfma_f32_32x32x16_bf16 a[48:63], a[132:135], a[196:199], a[48:63]
    s_waitcnt lgkmcnt(0)
    s_cmp_lt_u32 s39, 4
    s_cbranch_scc1 L_retry_B_o
L_back_B_o:
    ds_read_b64_tr_b16 a[144:145], v46 offset:49152
    ds_read_b64_tr_b16 a[146:147], v46 offset:50176
    buffer_load_dwordx4 a[224:227], v36, s[24:27], s84 offen sc1
    v_mfma_f32_32x32x16_bf16 a[32:47], a[128:131], a[196:199], a[32:47]
    ds_read_b64_tr_b16 a[148:149], v47 offset:49152
    ds_read_b64_tr_b16 a[150:151], v47 offset:50176
    v_mfma_f32_32x32x16_bf16 a[16:31], a[132:135], a[192:195], a[16:31]
    buffer_load_dwordx4 a[228:231], v37, s[24:27], s84 offen sc1
    v_mfma_f32_32x32x16_bf16 a[0:15], a[128:131], a[192:195], a[0:15]
    buffer_load_dwordx4 a[232:235], v36, s[24:27], s85 offen sc1
    s_waitcnt vmcnt(7)
    v_mfma_f32_32x32x16_bf16 a[48:63], a[140:143], a[204:207], a[48:63]
    ds_read_b64_tr_b16 a[152:153], v46 offset:51200
    ds_read_b64_tr_b16 a[154:155], v46 offset:52224
    v_mfma_f32_32x32x16_bf16 a[32:47], a[136:139], a[204:207], a[32:47]
    ds_read_b64_tr_b16 a[156:157], v47 offset:51200
    ds_read_b64_tr_b16 a[158:159], v47 offset:52224
    buffer_load_dwordx4 a[236:239], v37, s[24:27], s85 offen sc1
    v_mfma_f32_32x32x16_bf16 a[16:31], a[140:143], a[200:203], a[16:31]
    buffer_load_dwordx4 a[240:243], v36, s[24:27], s86 offen sc1
    v_mfma_f32_32x32x16_bf16 a[0:15], a[136:139], a[200:203], a[0:15]
    s_waitcnt vmcnt(7) lgkmcnt(4)
    v_mfma_f32_32x32x16_bf16 a[48:63], a[148:151], a[212:215], a[48:63]
    ds_read_b64_tr_b16 a[128:129], v46 offset:16384
    ds_read_b64_tr_b16 a[130:131], v46 offset:17408
    buffer_load_dwordx4 a[244:247], v37, s[24:27], s86 offen sc1
    v_and_b32 v88, 15, v0
    v_lshrrev_b32 v2, 5, v0
    v_mfma_f32_32x32x16_bf16 a[32:47], a[144:147], a[212:215], a[32:47]
    ds_read_b64_tr_b16 a[132:133], v47 offset:16384
    ds_read_b64_tr_b16 a[134:135], v47 offset:17408
    buffer_load_dwordx4 a[248:251], v36, s[24:27], s87 offen sc1
    v_xor_b32 v2, v2, v88
    v_lshlrev_b32 v2, 4, v2
    v_lshl_add_u32 v2, v88, 8, v2
    v_mfma_f32_32x32x16_bf16 a[16:31], a[148:151], a[208:211], a[16:31]
    v_add_u32 v2, s59, v2
    v_and_b32 v88, 16, v0
    v_mfma_f32_32x32x16_bf16 a[0:15], a[144:147], a[208:211], a[0:15]
    buffer_load_dwordx4 a[252:255], v37, s[24:27], s87 offen sc1
    v_mov_b32 v89, 0
    v_mov_b32 v90, 16384
    s_waitcnt vmcnt(8) lgkmcnt(4)
    v_mfma_f32_32x32x16_bf16 a[48:63], a[156:159], a[220:223], a[48:63]
    ds_read_b64_tr_b16 a[136:137], v46 offset:18432
    ds_read_b64_tr_b16 a[138:139], v46 offset:19456
    buffer_load_dwordx4 a[192:195], v36, s[24:27], s88 offen sc1
    v_cmp_eq_u32 vcc, 0, v88
    s_nop 1
    v_cndmask_b32 v89, v90, v89, vcc
    v_add_u32 v64, v89, v2
    v_mfma_f32_32x32x16_bf16 a[32:47], a[152:155], a[220:223], a[32:47]
    ds_read_b64_tr_b16 a[140:141], v47 offset:18432
    ds_read_b64_tr_b16 a[142:143], v47 offset:19456
    v_xor_b32 v65, 32, v64
    v_xor_b32 v66, 64, v64
    v_mfma_f32_32x32x16_bf16 a[16:31], a[156:159], a[216:219], a[16:31]
    buffer_load_dwordx4 a[196:199], v37, s[24:27], s88 offen sc1
    v_xor_b32 v67, 96, v64
    v_xor_b32 v68, 128, v64
    v_xor_b32 v69, 160, v64
    v_mfma_f32_32x32x16_bf16 a[0:15], a[152:155], a[216:219], a[0:15]
    buffer_load_dwordx4 a[200:203], v36, s[24:27], s89 offen sc1
    v_xor_b32 v70, 192, v64
    v_xor_b32 v71, 224, v64
    s_waitcnt vmcnt(9) lgkmcnt(4)
    v_mfma_f32_32x32x16_bf16 a[48:63], a[132:135], a[228:231], a[48:63]
    ds_read_b64_tr_b16 a[144:145], v48 offset:0
    ds_read_b64_tr_b16 a[146:147], v48 offset:1024
    v_mov_b32 v89, 49152
    v_mov_b32 v90, 98304
    v_mfma_f32_32x32x16_bf16 a[32:47], a[128:131], a[228:231], a[32:47]
    ds_read_b64_tr_b16 a[148:149], v49 offset:0
    ds_read_b64_tr_b16 a[150:151], v49 offset:1024
    buffer_load_dwordx4 a[204:207], v37, s[24:27], s89 offen sc1
    v_cmp_eq_u32 vcc, 0, v88
    s_nop 1
    v_cndmask_b32 v89, v90, v89, vcc
    v_add_u32 v72, v89, v2
    v_mfma_f32_32x32x16_bf16 a[16:31], a[132:135], a[224:227], a[16:31]
    buffer_load_dwordx4 a[208:211], v36, s[24:27], s90 offen sc1
    v_xor_b32 v73, 32, v72
    v_xor_b32 v74, 64, v72
    v_mfma_f32_32x32x16_bf16 a[0:15], a[128:131], a[224:227], a[0:15]
    v_xor_b32 v75, 96, v72
    v_xor_b32 v76, 128, v72
    v_xor_b32 v77, 160, v72
    s_waitcnt vmcnt(9) lgkmcnt(4)
    v_mfma_f32_32x32x16_bf16 a[48:63], a[140:143], a[236:239], a[48:63]
    ds_read_b64_tr_b16 a[152:153], v48 offset:2048
    ds_read_b64_tr_b16 a[154:155], v48 offset:3072
    buffer_load_dwordx4 a[212:215], v37, s[24:27], s90 offen sc1
    v_xor_b32 v78, 192, v72
    v_xor_b32 v79, 224, v72
    v_mfma_f32_32x32x16_bf16 a[32:47], a[136:139], a[236:239], a[32:47]
    ds_read_b64_tr_b16 a[156:157], v49 offset:2048
    ds_read_b64_tr_b16 a[158:159], v49 offset:3072
    buffer_load_dwordx4 a[216:219], v36, s[24:27], s91 offen sc1
    s_and_b32 s48, s50, 1
    v_lshrrev_b32 v88, 3, v0
    v_mfma_f32_32x32x16_bf16 a[16:31], a[140:143], a[232:235], a[16:31]
    v_lshl_add_u32 v88, s48, 3, v88
    v_and_b32 v2, 7, v0
    v_lshlrev_b32 v2, 1, v2
    v_mfma_f32_32x32x16_bf16 a[0:15], a[136:139], a[232:235], a[0:15]
    buffer_load_dwordx4 a[220:223], v37, s[24:27], s91 offen sc1
    v_xor_b32 v2, v2, v88
    v_lshlrev_b32 v2, 4, v2
    s_waitcnt vmcnt(10) lgkmcnt(4)
    v_mfma_f32_32x32x16_bf16 a[48:63], a[148:151], a[244:247], a[48:63]
    ds_read_b64_tr_b16 a[128:129], v44 offset:32768
    ds_read_b64_tr_b16 a[130:131], v44 offset:33792
    v_lshl_add_u32 v2, v88, 8, v2
    s_mov_b32 s48, 0
    v_mfma_f32_32x32x16_bf16 a[32:47], a[144:147], a[244:247], a[32:47]
    ds_read_b64_tr_b16 a[132:133], v45 offset:32768
    ds_read_b64_tr_b16 a[134:135], v45 offset:33792
    s_cmp_lt_u32 s50, 2
    s_cselect_b32 s48, s48, 16384
    v_add_u32 v80, s48, v2
    v_mfma_f32_32x32x16_bf16 a[16:31], a[148:151], a[240:243], a[16:31]
    v_xor_b32 v81, 16, v80
    s_mov_b32 s48, 49152
    v_mfma_f32_32x32x16_bf16 a[0:15], a[144:147], a[240:243], a[0:15]
    s_cmp_lt_u32 s50, 2
    s_cselect_b32 s48, s48, 98304
    v_add_u32 v82, s48, v2
    s_waitcnt vmcnt(8) lgkmcnt(4)
    v_mfma_f32_32x32x16_bf16 a[48:63], a[156:159], a[252:255], a[48:63]
    ds_read_b64_tr_b16 a[136:137], v44 offset:34816
    ds_read_b64_tr_b16 a[138:139], v44 offset:35840
    v_xor_b32 v83, 16, v82
    s_mov_b32 s48, 32768
    v_mfma_f32_32x32x16_bf16 a[32:47], a[152:155], a[252:255], a[32:47]
    ds_read_b64_tr_b16 a[140:141], v45 offset:34816
    ds_read_b64_tr_b16 a[142:143], v45 offset:35840
    v_mfma_f32_32x32x16_bf16 a[16:31], a[156:159], a[248:251], a[16:31]
    v_mfma_f32_32x32x16_bf16 a[0:15], a[152:155], a[248:251], a[0:15]
    s_waitcnt vmcnt(6) lgkmcnt(4)
    v_mfma_f32_32x32x16_bf16 a[48:63], a[132:135], a[196:199], a[48:63]
    ds_read_b64_tr_b16 a[144:145], v46 offset:0
    ds_read_b64_tr_b16 a[146:147], v46 offset:1024
    v_mfma_f32_32x32x16_bf16 a[32:47], a[128:131], a[196:199], a[32:47]
    ds_read_b64_tr_b16 a[148:149], v47 offset:0
    ds_read_b64_tr_b16 a[150:151], v47 offset:1024
    s_waitcnt vmcnt(4) lgkmcnt(4)
    v_mfma_f32_32x32x16_bf16 a[48:63], a[140:143], a[204:207], a[48:63]
    ds_read_b64_tr_b16 a[152:153], v46 offset:2048
    ds_read_b64_tr_b16 a[154:155], v46 offset:3072
    v_mfma_f32_32x32x16_bf16 a[32:47], a[136:139], a[204:207], a[32:47]
    ds_read_b64_tr_b16 a[156:157], v47 offset:2048
    ds_read_b64_tr_b16 a[158:159], v47 offset:3072
    s_waitcnt vmcnt(2) lgkmcnt(4)
    v_mfma_f32_32x32x16_bf16 a[48:63], a[148:151], a[212:215], a[48:63]
    v_mfma_f32_32x32x16_bf16 a[32:47], a[144:147], a[212:215], a[32:47]
    s_waitcnt vmcnt(0) lgkmcnt(0)
    v_mfma_f32_32x32x16_bf16 a[48:63], a[156:159], a[220:223], a[48:63]
    v_mfma_f32_32x32x16_bf16 a[32:47], a[152:155], a[220:223], a[32:47]
    v_mfma_f32_32x32x16_bf16 a[16:31], a[132:135], a[192:195], a[16:31]
    v_mfma_f32_32x32x16_bf16 a[0:15], a[128:131], a[192:195], a[0:15]
    s_nop 8
    ds_write_b128 v76, a[48:51]
    ds_write_b128 v77, a[52:55]
    v_mfma_f32_32x32x16_bf16 a[16:31], a[140:143], a[200:203], a[16:31]
    ds_write_b128 v78, a[56:59]
    v_mfma_f32_32x32x16_bf16 a[0:15], a[136:139], a[200:203], a[0:15]
    ds_write_b128 v79, a[60:63]
    ds_write_b128 v72, a[32:35]
    v_mfma_f32_32x32x16_bf16 a[16:31], a[148:151], a[208:211], a[16:31]
    ds_write_b128 v73, a[36:39]
    v_mfma_f32_32x32x16_bf16 a[0:15], a[144:147], a[208:211], a[0:15]
    ds_write_b128 v74, a[40:43]
    ds_write_b128 v75, a[44:47]
    v_mfma_f32_32x32x16_bf16 a[16:31], a[156:159], a[216:219], a[16:31]
    v_mfma_f32_32x32x16_bf16 a[0:15], a[152:155], a[216:219], a[0:15]
    s_waitcnt lgkmcnt(0)
    s_barrier
    ds_read_b128 v[224:227], v82 offset:0
    ds_read_b128 v[228:231], v82 offset:4096
    ds_read_b128 v[232:235], v82 offset:8192
    ds_read_b128 v[236:239], v82 offset:12288
    ds_read_b128 v[240:243], v83 offset:0
    ds_read_b128 v[244:247], v83 offset:4096
    ds_read_b128 v[248:251], v83 offset:8192
    ds_read_b128 v[252:255], v83 offset:12288
    s_waitcnt lgkmcnt(6)
    v_add_f32 v224, v224, v228
    v_add_f32 v225, v225, v229
    v_add_f32 v226, v226, v230
    v_add_f32 v227, v227, v231
    s_waitcnt lgkmcnt(4)
    v_add_f32 v232, v232, v236
    v_add_f32 v233, v233, v237
    v_add_f32 v234, v234, v238
    v_add_f32 v235, v235, v239
    v_add_f32 v224, v224, v232
    v_add_f32 v225, v225, v233
    v_add_f32 v226, v226, v234
    v_add_f32 v227, v227, v235
    v_cvt_pk_bf16_f32 v16, v224, v225
    v_cvt_pk_bf16_f32 v17, v226, v227
    s_waitcnt lgkmcnt(2)
    v_add_f32 v240, v240, v244
    v_add_f32 v241, v241, v245
    v_add_f32 v242, v242, v246
    v_add_f32 v243, v243, v247
    s_waitcnt lgkmcnt(0)
    v_add_f32 v248, v248, v252
    v_add_f32 v249, v249, v253
    v_add_f32 v250, v250, v254
    v_add_f32 v251, v251, v255
    v_add_f32 v240, v240, v248
    v_add_f32 v241, v241, v249
    ds_write_b128 v68, a[16:19]
    ds_write_b128 v69, a[20:23]
    ds_write_b128 v70, a[24:27]
    ds_write_b128 v71, a[28:31]
    ds_write_b128 v64, a[0:3]
    ds_write_b128 v65, a[4:7]
    ds_write_b128 v66, a[8:11]
    ds_write_b128 v67, a[12:15]
    v_add_f32 v242, v242, v250
    v_add_f32 v243, v243, v251
    v_cvt_pk_bf16_f32 v18, v240, v241
    v_cvt_pk_bf16_f32 v19, v242, v243
    buffer_store_dwordx4 v[16:19], v7, s[28:31], s48 offen
    s_waitcnt lgkmcnt(0)
    s_barrier
    ds_read_b128 v[192:195], v80 offset:0
    ds_read_b128 v[196:199], v80 offset:4096
    ds_read_b128 v[200:203], v80 offset:8192
    ds_read_b128 v[204:207], v80 offset:12288
    ds_read_b128 v[208:211], v81 offset:0
    ds_read_b128 v[212:215], v81 offset:4096
    ds_read_b128 v[216:219], v81 offset:8192
    ds_read_b128 v[220:223], v81 offset:12288
    s_waitcnt lgkmcnt(6)
    v_add_f32 v192, v192, v196
    v_add_f32 v193, v193, v197
    v_add_f32 v194, v194, v198
    v_add_f32 v195, v195, v199
    s_waitcnt lgkmcnt(4)
    v_add_f32 v200, v200, v204
    v_add_f32 v201, v201, v205
    v_add_f32 v202, v202, v206
    v_add_f32 v203, v203, v207
    v_add_f32 v192, v192, v200
    v_add_f32 v193, v193, v201
    v_add_f32 v194, v194, v202
    v_add_f32 v195, v195, v203
    v_cvt_pk_bf16_f32 v12, v192, v193
    v_cvt_pk_bf16_f32 v13, v194, v195
    s_waitcnt lgkmcnt(2)
    v_add_f32 v208, v208, v212
    v_add_f32 v209, v209, v213
    v_add_f32 v210, v210, v214
    v_add_f32 v211, v211, v215
    s_waitcnt lgkmcnt(0)
    v_add_f32 v216, v216, v220
    v_add_f32 v217, v217, v221
    v_add_f32 v218, v218, v222
    v_add_f32 v219, v219, v223
    v_add_f32 v208, v208, v216
    v_add_f32 v209, v209, v217
    v_add_f32 v210, v210, v218
    v_add_f32 v211, v211, v219
    v_cvt_pk_bf16_f32 v14, v208, v209
    v_cvt_pk_bf16_f32 v15, v210, v211
    buffer_store_dwordx4 v[12:15], v7, s[28:31], 0 offen
    s_endpgm
L_retry_A_tag:
    s_add_u32 s52, s52, 1
    s_cmp_gt_u32 s52, 0x40000
    s_cbranch_scc1 L_end
    buffer_load_dword v62, off, s[32:35], 0 sc1
    s_waitcnt vmcnt(0)
    v_readfirstlane_b32 s55, v62
    s_nop 0
    s_cmp_eq_u32 s55, 0
    s_cbranch_scc1 L_retry_A_tag
    s_nop 1
    s_branch L_back_A_tag
L_retry_A_gate:
    s_add_u32 s52, s52, 1
    s_cmp_gt_u32 s52, 0x40000
    s_cbranch_scc1 L_end
    buffer_load_dword v54, v53, s[24:27], 0 offen sc1
    s_waitcnt vmcnt(0)
    v_cmp_gt_i32 vcc, 0, v54
    s_nop 0
    s_andn2_b64 s[48:49], exec, vcc
    s_cbranch_scc1 L_retry_A_gate
    s_nop 1
    s_branch L_back_A_gate
L_retry_A_b0:
    s_add_u32 s52, s52, 1
    s_cmp_gt_u32 s52, 0x40000
    s_cbranch_scc1 L_end
    s_load_dword s39, s[24:25], s38 offset:0 glc
    s_waitcnt lgkmcnt(0)
    s_cmp_lt_u32 s39, 4
    s_cbranch_scc1 L_retry_A_b0
    s_nop 1
    s_branch L_back_A_b0
L_retry_A_b1:
    s_add_u32 s52, s52, 1
    s_cmp_gt_u32 s52, 0x40000
    s_cbranch_scc1 L_end
    s_load_dword s39, s[24:25], s38 offset:4 glc
    s_waitcnt lgkmcnt(0)
    s_cmp_lt_u32 s39, 4
    s_cbranch_scc1 L_retry_A_b1
    s_nop 1
    s_branch L_back_A_b1
L_retry_A_a0:
    s_add_u32 s52, s52, 1
    s_cmp_gt_u32 s52, 0x40000
    s_cbranch_scc1 L_end
    s_load_dword s39, s[24:25], s38 offset:8 glc
    s_waitcnt lgkmcnt(0)
    s_cmp_lt_u32 s39, 4
    s_cbranch_scc1 L_retry_A_a0
    s_nop 1
    s_branch L_back_A_a0
L_retry_A_o:
    s_add_u32 s52, s52, 1
    s_cmp_gt_u32 s52, 0x40000
    s_cbranch_scc1 L_end
    s_load_dword s39, s[24:25], s38 offset:12 glc
    s_waitcnt lgkmcnt(0)
    s_cmp_lt_u32 s39, 4
    s_cbranch_scc1 L_retry_A_o
    s_nop 1
    s_branch L_back_A_o
L_lead0:
    v_lshl_add_u32 v212, s50, 6, v0
    v_lshlrev_b32 v212, 7, v212
    v_mov_b32 v224, 0
    v_mov_b32 v225, 0
    v_mov_b32 v226, 0
    v_mov_b32 v227, 0
    buffer_store_dwordx4 v[224:227], v212, s[24:27], 0 offen sc1
    s_add_u32 s49, s58, 32768
    buffer_store_dwordx4 v[224:227], v1, s[24:27], s49 offen sc1
    buffer_store_dwordx4 v[224:227], v1, s[24:27], s49 offen offset:1024 sc1
    s_branch L_lead0_back
L_lead2:
    v_mov_b32 v3, 1
    s_mov_b64 exec, 1
    buffer_store_dword v3, off, s[32:35], 0 sc1
    s_mov_b64 exec, -1
    s_branch L_lead2_back
L_retry_B_tag:
    s_add_u32 s52, s52, 1
    s_cmp_gt_u32 s52, 0x40000
    s_cbranch_scc1 L_end
    buffer_load_dword v62, off, s[32:35], 0 sc1
    s_waitcnt vmcnt(0)
    v_readfirstlane_b32 s55, v62
    s_nop 0
    s_cmp_eq_u32 s55, 0
    s_cbranch_scc1 L_retry_B_tag
    s_nop 1
    s_branch L_back_B_tag
L_retry_B_b0:
    s_add_u32 s52, s52, 1
    s_cmp_gt_u32 s52, 0x40000
    s_cbranch_scc1 L_end
    s_load_dword s39, s[24:25], s38 offset:0 glc
    s_waitcnt lgkmcnt(0)
    s_cmp_lt_u32 s39, 4
    s_cbranch_scc1 L_retry_B_b0
    s_nop 1
    s_branch L_back_B_b0
L_retry_B_kv:
    s_add_u32 s52, s52, 1
    s_cmp_gt_u32 s52, 0x40000
    s_cbranch_scc1 L_end
    s_load_dword s40, s[24:25], s37 glc
    s_waitcnt lgkmcnt(0)
    s_cmp_lt_u32 s40, 16
    s_cbranch_scc1 L_retry_B_kv
    s_nop 1
    s_branch L_back_B_kv
L_retry_B_b1:
    s_add_u32 s52, s52, 1
    s_cmp_gt_u32 s52, 0x40000
    s_cbranch_scc1 L_end
    s_load_dword s39, s[24:25], s38 offset:4 glc
    s_waitcnt lgkmcnt(0)
    s_cmp_lt_u32 s39, 4
    s_cbranch_scc1 L_retry_B_b1
    s_nop 1
    s_branch L_back_B_b1
L_retry_B_a0:
    s_add_u32 s52, s52, 1
    s_cmp_gt_u32 s52, 0x40000
    s_cbranch_scc1 L_end
    s_load_dword s39, s[24:25], s38 offset:8 glc
    s_waitcnt lgkmcnt(0)
    s_cmp_lt_u32 s39, 4
    s_cbranch_scc1 L_retry_B_a0
    s_nop 1
    s_branch L_back_B_a0
L_retry_B_o:
    s_add_u32 s52, s52, 1
    s_cmp_gt_u32 s52, 0x40000
    s_cbranch_scc1 L_end
    s_load_dword s39, s[24:25], s38 offset:12 glc
    s_waitcnt lgkmcnt(0)
    s_cmp_lt_u32 s39, 4
    s_cbranch_scc1 L_retry_B_o
    s_nop 1
    s_branch L_back_B_o
L_end:
    s_endpgm
.if (. - gated_mix__linear_kernel_hedgehog__dense_activation_mish__prompt_kernel) > 44032
.error "code_kb too small"
.endif
.fill (44032 - (. - gated_mix__linear_kernel_hedgehog__dense_activation_mish__prompt_kernel)) / 4, 4, 0xbf810000
    s_endpgm
.section .rodata,"a"
.p2align 6
.amdhsa_kernel gated_mix__linear_kernel_hedgehog__dense_activation_mish__prompt_kernel
  .amdhsa_next_free_vgpr 512
  .amdhsa_next_free_sgpr 102
  .amdhsa_accum_offset 256
  .amdhsa_group_segment_fixed_size 0
  .amdhsa_kernarg_size 96
  .amdhsa_user_sgpr_count 2
  .amdhsa_user_sgpr_kernarg_segment_ptr 1
  .amdhsa_system_sgpr_workgroup_id_x 1
.end_amdhsa_kernel
```
